```python
import torch

def _softmax(x, axis=-1):
    return torch.softmax(x, dim=axis)
def _gelu(x):
    return torch.nn.functional.gelu(x, approximate="tanh")
def _silu(x):
    return torch.nn.functional.silu(x)
def _sigmoid(x):
    return torch.sigmoid(x)
def _layernorm(x, axis=-1, eps=1e-5):
    m = x.mean(dim=axis, keepdim=True)
    v = x.var(dim=axis, keepdim=True, unbiased=False)
    return (x - m) / torch.sqrt(v + eps)
def _scatter_add(tgt, idx, src, axis=0):
    return tgt.clone().index_add_(axis, idx, src)
def _segment_sum(src, seg, n):
    out = torch.zeros((n,) + src.shape[1:], dtype=src.dtype)
    return out.index_add_(0, seg, src)
def _pad(x, pw):
    flat = tuple(v for pair in reversed(pw) for v in pair)
    return torch.nn.functional.pad(x, flat)

kernel_name = 'standalone__mha_block_cached__near_ridge'

def setup_inputs():

    _w = (lambda a: (lambda t: t.to(torch.bfloat16) if t.is_floating_point() else t)(torch.as_tensor(a)))
    B, Sq, D = 16, 48, 640
    H, Sk, Dh = 32, 48, 192
    return {
        "x": _w((lambda *s: torch.randn(*s, dtype=torch.bfloat16) * 0.8)(B, Sq, D)),
        "k_cache": _w((lambda *s: torch.randn(*s, dtype=torch.bfloat16) * 0.8)(B, H, Sk, Dh)),
        "v_cache": _w((lambda *s: torch.randn(*s, dtype=torch.bfloat16) * 0.05)(B, H, Sk, Dh)),
        "wq": _w((lambda *s: torch.randn(*s, dtype=torch.bfloat16) * 0.8)(D, H * Dh) * (D ** -0.5)),
        "wo": _w((lambda *s: torch.randn(*s, dtype=torch.bfloat16) * 0.05)(H * Dh, D) * ((H * Dh) ** -0.5)),
    }

def reference(x, k_cache, v_cache, wq, wo):
    B, Sq, D = x.shape
    H, Dh = 32, 192
    q = (lambda x, *d: x.permute(*d))((x @ wq).reshape(B, Sq, H, Dh), 0, 2, 1, 3)
    scores = torch.einsum("bhqd,bhkd->bhqk", q, k_cache) * (Dh ** -0.5)
    p = _softmax(scores, axis=-1)
    o = torch.einsum("bhqk,bhkd->bhqd", p, v_cache)
    return (lambda x, *d: x.permute(*d))(o, 0, 2, 1, 3).reshape(B, Sq, H * Dh) @ wo
```

```asm
; @launch grid=(256,1,1) block=(512,1,1) lds=163840
.amdgcn_target "amdgcn-amd-amdhsa--gfx950"
.text
.globl standalone__mha_block_cached__near_ridge_kernel
.p2align 8
.type standalone__mha_block_cached__near_ridge_kernel,@function
standalone__mha_block_cached__near_ridge_kernel:
    s_load_dwordx16 s[4:19], s[0:1], 0
    s_cmp_ge_u32 s2, 256
    s_cbranch_scc1 L_end
    v_lshrrev_b32 v2, 6, v0
    v_and_b32 v1, 63, v0
    v_readfirstlane_b32 s52, v2
    s_and_b32 s48, s2, 7
    s_lshr_b32 s3, s2, 3
    s_and_b32 s49, s3, 3
    s_lshr_b32 s50, s3, 2
    s_lshl_b32 s51, s48, 2
    s_add_u32 s51, s51, s49
    s_cmp_lt_u32 s52, 4
    s_cbranch_scc1 L_compute
    s_sub_u32 s60, s52, 4
    v_lshrrev_b32 v2, 3, v1
    v_and_b32 v3, 7, v1
    v_lshrrev_b32 v4, 1, v2
    v_lshlrev_b32 v5, 1, v4
    v_xor_b32 v5, v5, v3
    v_lshlrev_b32 v5, 4, v5
    v_lshrrev_b32 v6, 2, v2
    v_lshlrev_b32 v6, 3, v6
    v_and_b32 v7, 3, v2
    v_add_u32 v6, v6, v7
    v_mul_u32_u24 v6, 12288, v6
    v_add_u32 v10, v6, v5
    v_mul_u32_u24 v6, 1280, v2
    v_xor_b32 v7, v3, v4
    v_lshlrev_b32 v8, 4, v7
    s_and_b32 s54, s60, 1
    s_lshl_b32 s55, s54, 6
    v_xor_b32 v8, s55, v8
    v_add_u32 v11, v6, v8
    v_xor_b32 v9, 64, v8
    v_add_u32 v12, v6, v9
    s_mul_i32 s67, s50, 122880
    s_mul_i32 s55, s60, 30720
    s_add_u32 s67, s67, s55
    s_mul_i32 s68, s51, 384
    s_lshr_b32 s53, s60, 1
    s_mul_i32 s55, s53, 196608
    s_add_u32 s68, s68, s55
    s_mul_i32 s55, s54, 49152
    s_add_u32 s68, s68, s55
    s_and_b32 s61, s50, 3
    s_mul_i32 s61, s61, 20
    s_lshr_b32 s61, s61, 3
    s_and_b32 s55, s49, 3
    s_mul_i32 s55, s55, 20
    s_lshr_b32 s55, s55, 3
    s_add_u32 s61, s61, s55
    s_sub_u32 s55, s61, 10
    s_cmp_ge_u32 s61, 10
    s_cselect_b32 s61, s55, s61
    s_lshl_b32 s61, s61, 7
    s_mul_i32 s65, s60, 3072
    s_lshl_b32 s66, s60, 10
    s_waitcnt lgkmcnt(0)
    s_mov_b32 s20, s4
    s_mov_b32 s21, s5
    s_mov_b32 s22, 983040
    s_mov_b32 s23, 0x00020000
    s_mov_b32 s24, s10
    s_mov_b32 s25, s11
    s_mov_b32 s26, 7864320
    s_mov_b32 s27, 0x00020000
    s_mul_i32 s62, s61, 6144
    s_add_u32 s62, s62, s68
    s_add_u32 s63, s61, s67
    s_add_u32 m0, s65, 40960
    s_add_u32 s64, s63, 0
    buffer_load_dwordx4 v11, s[20:23], s64 offen  lds
    s_add_u32 m0, s66, 53248
    s_add_u32 s64, s62, 0
    buffer_load_dwordx4 v10, s[24:27], s64 offen  lds
    s_add_u32 m0, s66, 57344
    s_add_u32 s64, s62, 128
    buffer_load_dwordx4 v10, s[24:27], s64 offen  lds
    s_add_u32 m0, s65, 41984
    s_add_u32 s64, s63, 10240
    buffer_load_dwordx4 v12, s[20:23], s64 offen  lds
    s_add_u32 m0, s66, 61440
    s_add_u32 s64, s62, 256
    buffer_load_dwordx4 v10, s[24:27], s64 offen  lds
    s_add_u32 m0, s65, 43008
    s_add_u32 s64, s63, 20480
    buffer_load_dwordx4 v11, s[20:23], s64 offen  lds
    s_add_u32 m0, s66, 65536
    s_add_u32 s64, s62, 393216
    buffer_load_dwordx4 v10, s[24:27], s64 offen  lds
    s_add_u32 m0, s66, 69632
    s_add_u32 s64, s62, 393344
    buffer_load_dwordx4 v10, s[24:27], s64 offen  lds
    s_add_u32 m0, s66, 73728
    s_add_u32 s64, s62, 393472
    buffer_load_dwordx4 v10, s[24:27], s64 offen  lds
    s_add_u32 s61, s61, 128
    s_cmp_eq_u32 s61, 1280
    s_cselect_b32 s61, 0, s61
    s_mov_b32 s28, s6
    s_mov_b32 s29, s7
    s_mov_b32 s30, 9437184
    s_mov_b32 s31, 0x00020000
    s_mov_b32 s32, s8
    s_mov_b32 s33, s9
    s_mov_b32 s34, 9437184
    s_mov_b32 s35, 0x00020000
    v_mov_b32 v16, 0x7ffffff0
    s_lshl_b32 s6, s60, 2
    s_add_u32 s6, s6, 36864
    s_barrier
    s_add_u32 m0, s6, 0
    s_mov_b64 exec, 1
    buffer_load_dword v16, s[20:23], 0 offen lds
    s_mov_b64 exec, -1
    s_mul_i32 s62, s61, 6144
    s_add_u32 s62, s62, s68
    s_add_u32 s63, s61, s67
    s_add_u32 m0, s65, 81920
    s_add_u32 s64, s63, 0
    buffer_load_dwordx4 v11, s[20:23], s64 offen  lds
    s_add_u32 m0, s66, 94208
    s_add_u32 s64, s62, 0
    buffer_load_dwordx4 v10, s[24:27], s64 offen  lds
    s_add_u32 m0, s66, 98304
    s_add_u32 s64, s62, 128
    buffer_load_dwordx4 v10, s[24:27], s64 offen  lds
    s_add_u32 m0, s65, 82944
    s_add_u32 s64, s63, 10240
    buffer_load_dwordx4 v12, s[20:23], s64 offen  lds
    s_add_u32 m0, s66, 102400
    s_add_u32 s64, s62, 256
    buffer_load_dwordx4 v10, s[24:27], s64 offen  lds
    s_add_u32 m0, s65, 83968
    s_add_u32 s64, s63, 20480
    buffer_load_dwordx4 v11, s[20:23], s64 offen  lds
    s_add_u32 m0, s66, 106496
    s_add_u32 s64, s62, 393216
    buffer_load_dwordx4 v10, s[24:27], s64 offen  lds
    s_add_u32 m0, s66, 110592
    s_add_u32 s64, s62, 393344
    buffer_load_dwordx4 v10, s[24:27], s64 offen  lds
    s_add_u32 m0, s66, 114688
    s_add_u32 s64, s62, 393472
    buffer_load_dwordx4 v10, s[24:27], s64 offen  lds
    s_add_u32 s61, s61, 128
    s_cmp_eq_u32 s61, 1280
    s_cselect_b32 s61, 0, s61
    s_add_u32 m0, s6, 16
    s_mov_b64 exec, 1
    buffer_load_dword v16, s[20:23], 0 offen lds
    s_mov_b64 exec, -1
    s_lshl_b32 s55, s50, 7
    s_add_u32 s55, s55, 3276800
    s_load_dword s59, s[18:19], s55
    s_mov_b32 s36, s12
    s_mov_b32 s37, s13
    s_mov_b32 s38, 7864320
    s_mov_b32 s39, 0x00020000
    s_mov_b32 s44, s18
    s_mov_b32 s45, s19
    s_mov_b32 s46, 268435456
    s_mov_b32 s47, 0x00020000
    s_add_u32 s10, s49, s50
    s_lshr_b32 s11, s50, 2
    v_mul_u32_u24 v6, 384, v2
    v_add_u32 v14, v6, v8
    v_add_u32 v15, v6, v9
    s_lshl_b32 s55, s50, 1
    s_add_u32 s55, s55, s53
    s_lshl_b32 s55, s55, 3
    s_add_u32 s55, s55, s48
    s_mul_i32 s5, s55, 73728
    s_lshl_b32 s12, s55, 7
    s_add_u32 s12, s12, 3145728
    s_mul_i32 s13, s55, 20480
    s_mul_i32 s56, s54, 9216
    s_add_u32 s5, s5, s56
    s_mul_i32 s56, s49, 18432
    s_add_u32 s4, s5, s56
    s_mul_i32 s7, s53, 18432
    s_mul_i32 s56, s54, 3072
    s_add_u32 s7, s7, s56
    s_mul_i32 s9, s48, 983040
    s_mul_i32 s55, s60, 20480
    s_add_u32 s9, s9, s55
    s_mul_i32 s55, s49, 320
    s_add_u32 s9, s9, s55
    s_mul_i32 s8, s60, 5120
    s_mov_b32 s53, 0x0ccccccd
    v_add_u32 v2, 0, v1
    v_mul_hi_u32 v3, v2, s53
    v_mul_u32_u24 v4, 20, v3
    v_sub_u32 v4, v2, v4
    v_lshrrev_b32 v5, 2, v3
    v_and_b32 v5, 2, v5
    v_xor_b32 v4, v4, v5
    v_mul_u32_u24 v3, 1280, v3
    v_lshl_add_u32 v20, v4, 4, v3
    v_add_u32 v2, 64, v1
    v_mul_hi_u32 v3, v2, s53
    v_mul_u32_u24 v4, 20, v3
    v_sub_u32 v4, v2, v4
    v_lshrrev_b32 v5, 2, v3
    v_and_b32 v5, 2, v5
    v_xor_b32 v4, v4, v5
    v_mul_u32_u24 v3, 1280, v3
    v_lshl_add_u32 v21, v4, 4, v3
    v_add_u32 v2, 128, v1
    v_mul_hi_u32 v3, v2, s53
    v_mul_u32_u24 v4, 20, v3
    v_sub_u32 v4, v2, v4
    v_lshrrev_b32 v5, 2, v3
    v_and_b32 v5, 2, v5
    v_xor_b32 v4, v4, v5
    v_mul_u32_u24 v3, 1280, v3
    v_lshl_add_u32 v22, v4, 4, v3
    v_add_u32 v2, 192, v1
    v_mul_hi_u32 v3, v2, s53
    v_mul_u32_u24 v4, 20, v3
    v_sub_u32 v4, v2, v4
    v_lshrrev_b32 v5, 2, v3
    v_and_b32 v5, 2, v5
    v_xor_b32 v4, v4, v5
    v_mul_u32_u24 v3, 1280, v3
    v_lshl_add_u32 v23, v4, 4, v3
    v_add_u32 v2, 256, v1
    v_mul_hi_u32 v3, v2, s53
    v_mul_u32_u24 v4, 20, v3
    v_sub_u32 v4, v2, v4
    v_lshrrev_b32 v5, 2, v3
    v_and_b32 v5, 2, v5
    v_xor_b32 v4, v4, v5
    v_mul_u32_u24 v3, 1280, v3
    v_lshl_add_u32 v24, v4, 4, v3
    v_min_u32 v2, 59, v1
    v_lshlrev_b32 v17, 7, v2
    v_lshlrev_b32 v26, 7, v1
    v_and_b32 v2, 7, v1
    v_lshlrev_b32 v27, 7, v2
    s_and_b32 s55, s3, 3
    s_lshl_b32 s55, s55, 2
    s_lshr_b32 s14, 0x9843, s55
    s_and_b32 s14, s14, 15
    s_and_b32 s55, s3, 3
    s_lshl_b32 s55, s55, 2
    s_lshr_b32 s15, 0x7698, s55
    s_and_b32 s15, s15, 15
    v_min_u32 v2, 23, v1
    v_mul_u32_u24 v28, 384, v2
    s_mul_i32 s62, s61, 6144
    s_add_u32 s62, s62, s68
    s_add_u32 s63, s61, s67
    s_add_u32 m0, s65, 122880
    s_add_u32 s64, s63, 0
    buffer_load_dwordx4 v11, s[20:23], s64 offen  lds
    s_add_u32 m0, s66, 135168
    s_add_u32 s64, s62, 0
    buffer_load_dwordx4 v10, s[24:27], s64 offen  lds
    s_add_u32 m0, s66, 139264
    s_add_u32 s64, s62, 128
    buffer_load_dwordx4 v10, s[24:27], s64 offen  lds
    s_add_u32 m0, s65, 123904
    s_add_u32 s64, s63, 10240
    buffer_load_dwordx4 v12, s[20:23], s64 offen  lds
    s_add_u32 m0, s66, 143360
    s_add_u32 s64, s62, 256
    buffer_load_dwordx4 v10, s[24:27], s64 offen  lds
    s_add_u32 m0, s65, 124928
    s_add_u32 s64, s63, 20480
    buffer_load_dwordx4 v11, s[20:23], s64 offen  lds
    s_add_u32 m0, s66, 147456
    s_add_u32 s64, s62, 393216
    buffer_load_dwordx4 v10, s[24:27], s64 offen  lds
    s_add_u32 m0, s66, 151552
    s_add_u32 s64, s62, 393344
    buffer_load_dwordx4 v10, s[24:27], s64 offen  lds
    s_add_u32 m0, s66, 155648
    s_add_u32 s64, s62, 393472
    buffer_load_dwordx4 v10, s[24:27], s64 offen  lds
    s_add_u32 s61, s61, 128
    s_cmp_eq_u32 s61, 1280
    s_cselect_b32 s61, 0, s61
    s_add_u32 m0, s6, 32
    s_mov_b64 exec, 1
    buffer_load_dword v16, s[20:23], 0 offen lds
    s_mov_b64 exec, -1
    s_mul_i32 s62, s61, 6144
    s_add_u32 s62, s62, s68
    s_add_u32 s63, s61, s67
    s_add_u32 m0, s65, 0
    s_add_u32 s64, s63, 0
    buffer_load_dwordx4 v11, s[20:23], s64 offen  lds
    s_add_u32 m0, s66, 12288
    s_add_u32 s64, s62, 0
    buffer_load_dwordx4 v10, s[24:27], s64 offen  lds
    s_add_u32 m0, s66, 16384
    s_add_u32 s64, s62, 128
    buffer_load_dwordx4 v10, s[24:27], s64 offen  lds
    s_add_u32 m0, s65, 1024
    s_add_u32 s64, s63, 10240
    buffer_load_dwordx4 v12, s[20:23], s64 offen  lds
    s_add_u32 m0, s66, 20480
    s_add_u32 s64, s62, 256
    buffer_load_dwordx4 v10, s[24:27], s64 offen  lds
    s_add_u32 m0, s65, 2048
    s_add_u32 s64, s63, 20480
    buffer_load_dwordx4 v11, s[20:23], s64 offen  lds
    s_add_u32 m0, s66, 24576
    s_add_u32 s64, s62, 393216
    buffer_load_dwordx4 v10, s[24:27], s64 offen  lds
    s_add_u32 m0, s66, 28672
    s_add_u32 s64, s62, 393344
    buffer_load_dwordx4 v10, s[24:27], s64 offen  lds
    s_add_u32 m0, s66, 32768
    s_add_u32 s64, s62, 393472
    buffer_load_dwordx4 v10, s[24:27], s64 offen  lds
    s_add_u32 s61, s61, 128
    s_cmp_eq_u32 s61, 1280
    s_cselect_b32 s61, 0, s61
    s_add_u32 m0, s6, 48
    s_mov_b64 exec, 1
    buffer_load_dword v16, s[20:23], 0 offen lds
    s_mov_b64 exec, -1
    s_cmp_lg_u32 s14, 3
    s_cbranch_scc1 L_nw3
    s_lshl_b32 s55, s3, 2
    s_add_u32 s55, s55, s60
    s_mul_i32 s55, s55, 7680
    s_mul_i32 s56, s48, 983040
    s_add_u32 s55, s55, s56
    buffer_load_dword v18, v17, s[36:39], s55 offen
L_nw3:
    s_barrier
    s_mul_i32 s62, s61, 6144
    s_add_u32 s62, s62, s68
    s_add_u32 s63, s61, s67
    s_add_u32 m0, s65, 40960
    s_add_u32 s64, s63, 0
    buffer_load_dwordx4 v11, s[20:23], s64 offen  lds
    s_add_u32 m0, s66, 53248
    s_add_u32 s64, s62, 0
    buffer_load_dwordx4 v10, s[24:27], s64 offen  lds
    s_add_u32 m0, s66, 57344
    s_add_u32 s64, s62, 128
    buffer_load_dwordx4 v10, s[24:27], s64 offen  lds
    s_add_u32 m0, s65, 41984
    s_add_u32 s64, s63, 10240
    buffer_load_dwordx4 v12, s[20:23], s64 offen  lds
    s_add_u32 m0, s66, 61440
    s_add_u32 s64, s62, 256
    buffer_load_dwordx4 v10, s[24:27], s64 offen  lds
    s_add_u32 m0, s65, 43008
    s_add_u32 s64, s63, 20480
    buffer_load_dwordx4 v11, s[20:23], s64 offen  lds
    s_add_u32 m0, s66, 65536
    s_add_u32 s64, s62, 393216
    buffer_load_dwordx4 v10, s[24:27], s64 offen  lds
    s_add_u32 m0, s66, 69632
    s_add_u32 s64, s62, 393344
    buffer_load_dwordx4 v10, s[24:27], s64 offen  lds
    s_add_u32 m0, s66, 73728
    s_add_u32 s64, s62, 393472
    buffer_load_dwordx4 v10, s[24:27], s64 offen  lds
    s_add_u32 s61, s61, 128
    s_cmp_eq_u32 s61, 1280
    s_cselect_b32 s61, 0, s61
    s_add_u32 m0, s6, 64
    s_mov_b64 exec, 1
    buffer_load_dword v16, s[20:23], 0 offen lds
    s_mov_b64 exec, -1
    s_cmp_lg_u32 s14, 4
    s_cbranch_scc1 L_nw4
    s_lshl_b32 s55, s3, 2
    s_add_u32 s55, s55, s60
    s_mul_i32 s55, s55, 7680
    s_mul_i32 s56, s48, 983040
    s_add_u32 s55, s55, s56
    buffer_load_dword v18, v17, s[36:39], s55 offen
L_nw4:
    s_mul_i32 s62, s61, 6144
    s_add_u32 s62, s62, s68
    s_add_u32 s63, s61, s67
    s_add_u32 m0, s65, 81920
    s_add_u32 s64, s63, 0
    buffer_load_dwordx4 v11, s[20:23], s64 offen  lds
    s_add_u32 m0, s66, 94208
    s_add_u32 s64, s62, 0
    buffer_load_dwordx4 v10, s[24:27], s64 offen  lds
    s_add_u32 m0, s66, 98304
    s_add_u32 s64, s62, 128
    buffer_load_dwordx4 v10, s[24:27], s64 offen  lds
    s_add_u32 m0, s65, 82944
    s_add_u32 s64, s63, 10240
    buffer_load_dwordx4 v12, s[20:23], s64 offen  lds
    s_add_u32 m0, s66, 102400
    s_add_u32 s64, s62, 256
    buffer_load_dwordx4 v10, s[24:27], s64 offen  lds
    s_add_u32 m0, s65, 83968
    s_add_u32 s64, s63, 20480
    buffer_load_dwordx4 v11, s[20:23], s64 offen  lds
    s_add_u32 m0, s66, 106496
    s_add_u32 s64, s62, 393216
    buffer_load_dwordx4 v10, s[24:27], s64 offen  lds
    s_add_u32 m0, s66, 110592
    s_add_u32 s64, s62, 393344
    buffer_load_dwordx4 v10, s[24:27], s64 offen  lds
    s_add_u32 m0, s66, 114688
    s_add_u32 s64, s62, 393472
    buffer_load_dwordx4 v10, s[24:27], s64 offen  lds
    s_add_u32 s61, s61, 128
    s_cmp_eq_u32 s61, 1280
    s_cselect_b32 s61, 0, s61
    s_add_u32 m0, s6, 80
    s_mov_b64 exec, 1
    buffer_load_dword v16, s[20:23], 0 offen lds
    s_mov_b64 exec, -1
    s_barrier
    s_mul_i32 s62, s61, 6144
    s_add_u32 s62, s62, s68
    s_add_u32 s63, s61, s67
    s_add_u32 m0, s65, 0
    s_add_u32 s64, s63, 0
    buffer_load_dwordx4 v11, s[20:23], s64 offen  lds
    s_add_u32 m0, s66, 12288
    s_add_u32 s64, s62, 0
    buffer_load_dwordx4 v10, s[24:27], s64 offen  lds
    s_add_u32 m0, s66, 16384
    s_add_u32 s64, s62, 128
    buffer_load_dwordx4 v10, s[24:27], s64 offen  lds
    s_add_u32 m0, s65, 1024
    s_add_u32 s64, s63, 10240
    buffer_load_dwordx4 v12, s[20:23], s64 offen  lds
    s_add_u32 m0, s66, 20480
    s_add_u32 s64, s62, 256
    buffer_load_dwordx4 v10, s[24:27], s64 offen  lds
    s_add_u32 m0, s65, 2048
    s_add_u32 s64, s63, 20480
    buffer_load_dwordx4 v11, s[20:23], s64 offen  lds
    s_add_u32 m0, s66, 24576
    s_add_u32 s64, s62, 393216
    buffer_load_dwordx4 v10, s[24:27], s64 offen  lds
    s_add_u32 m0, s66, 28672
    s_add_u32 s64, s62, 393344
    buffer_load_dwordx4 v10, s[24:27], s64 offen  lds
    s_add_u32 m0, s66, 32768
    s_add_u32 s64, s62, 393472
    buffer_load_dwordx4 v10, s[24:27], s64 offen  lds
    s_add_u32 s61, s61, 128
    s_cmp_eq_u32 s61, 1280
    s_cselect_b32 s61, 0, s61
    s_add_u32 m0, s6, 96
    s_mov_b64 exec, 1
    buffer_load_dword v16, s[20:23], 0 offen lds
    s_mov_b64 exec, -1
    s_cmp_lg_u32 s15, 6
    s_cbranch_scc1 L_nv6
    s_add_u32 m0, s7, 122880
    s_add_u32 s64, s4, 0
    buffer_load_dwordx4 v14, s[28:31], s64 offen nt lds
    s_add_u32 m0, s7, 129024
    s_add_u32 s64, s4, 128
    buffer_load_dwordx4 v14, s[28:31], s64 offen nt lds
    s_add_u32 m0, s7, 135168
    s_add_u32 s64, s4, 256
    buffer_load_dwordx4 v14, s[28:31], s64 offen nt lds
    s_add_u32 m0, s7, 123904
    s_add_u32 s64, s4, 3072
    buffer_load_dwordx4 v15, s[28:31], s64 offen nt lds
    s_add_u32 m0, s7, 130048
    s_add_u32 s64, s4, 3200
    buffer_load_dwordx4 v15, s[28:31], s64 offen nt lds
    s_add_u32 m0, s7, 136192
    s_add_u32 s64, s4, 3328
    buffer_load_dwordx4 v15, s[28:31], s64 offen nt lds
    s_add_u32 m0, s7, 124928
    s_add_u32 s64, s4, 6144
    buffer_load_dwordx4 v14, s[28:31], s64 offen nt lds
    s_add_u32 m0, s7, 131072
    s_add_u32 s64, s4, 6272
    buffer_load_dwordx4 v14, s[28:31], s64 offen nt lds
    s_add_u32 m0, s7, 137216
    s_add_u32 s64, s4, 6400
    buffer_load_dwordx4 v14, s[28:31], s64 offen nt lds
    s_add_u32 m0, s6, 160
    s_mov_b64 exec, 1
    buffer_load_dword v16, s[20:23], 0 offen lds
    s_mov_b64 exec, -1
L_nv6:
    s_barrier
    s_mul_i32 s62, s61, 6144
    s_add_u32 s62, s62, s68
    s_add_u32 s63, s61, s67
    s_add_u32 m0, s65, 40960
    s_add_u32 s64, s63, 0
    buffer_load_dwordx4 v11, s[20:23], s64 offen  lds
    s_add_u32 m0, s66, 53248
    s_add_u32 s64, s62, 0
    buffer_load_dwordx4 v10, s[24:27], s64 offen  lds
    s_add_u32 m0, s66, 57344
    s_add_u32 s64, s62, 128
    buffer_load_dwordx4 v10, s[24:27], s64 offen  lds
    s_add_u32 m0, s65, 41984
    s_add_u32 s64, s63, 10240
    buffer_load_dwordx4 v12, s[20:23], s64 offen  lds
    s_add_u32 m0, s66, 61440
    s_add_u32 s64, s62, 256
    buffer_load_dwordx4 v10, s[24:27], s64 offen  lds
    s_add_u32 m0, s65, 43008
    s_add_u32 s64, s63, 20480
    buffer_load_dwordx4 v11, s[20:23], s64 offen  lds
    s_add_u32 m0, s66, 65536
    s_add_u32 s64, s62, 393216
    buffer_load_dwordx4 v10, s[24:27], s64 offen  lds
    s_add_u32 m0, s66, 69632
    s_add_u32 s64, s62, 393344
    buffer_load_dwordx4 v10, s[24:27], s64 offen  lds
    s_add_u32 m0, s66, 73728
    s_add_u32 s64, s62, 393472
    buffer_load_dwordx4 v10, s[24:27], s64 offen  lds
    s_add_u32 s61, s61, 128
    s_cmp_eq_u32 s61, 1280
    s_cselect_b32 s61, 0, s61
    s_add_u32 m0, s6, 112
    s_mov_b64 exec, 1
    buffer_load_dword v16, s[20:23], 0 offen lds
    s_mov_b64 exec, -1
    s_cmp_lg_u32 s15, 7
    s_cbranch_scc1 L_nv7
    s_add_u32 m0, s7, 122880
    s_add_u32 s64, s4, 0
    buffer_load_dwordx4 v14, s[28:31], s64 offen nt lds
    s_add_u32 m0, s7, 129024
    s_add_u32 s64, s4, 128
    buffer_load_dwordx4 v14, s[28:31], s64 offen nt lds
    s_add_u32 m0, s7, 135168
    s_add_u32 s64, s4, 256
    buffer_load_dwordx4 v14, s[28:31], s64 offen nt lds
    s_add_u32 m0, s7, 123904
    s_add_u32 s64, s4, 3072
    buffer_load_dwordx4 v15, s[28:31], s64 offen nt lds
    s_add_u32 m0, s7, 130048
    s_add_u32 s64, s4, 3200
    buffer_load_dwordx4 v15, s[28:31], s64 offen nt lds
    s_add_u32 m0, s7, 136192
    s_add_u32 s64, s4, 3328
    buffer_load_dwordx4 v15, s[28:31], s64 offen nt lds
    s_add_u32 m0, s7, 124928
    s_add_u32 s64, s4, 6144
    buffer_load_dwordx4 v14, s[28:31], s64 offen nt lds
    s_add_u32 m0, s7, 131072
    s_add_u32 s64, s4, 6272
    buffer_load_dwordx4 v14, s[28:31], s64 offen nt lds
    s_add_u32 m0, s7, 137216
    s_add_u32 s64, s4, 6400
    buffer_load_dwordx4 v14, s[28:31], s64 offen nt lds
    s_add_u32 m0, s6, 160
    s_mov_b64 exec, 1
    buffer_load_dword v16, s[20:23], 0 offen lds
    s_mov_b64 exec, -1
L_nv7:
    s_barrier
    s_mul_i32 s62, s61, 6144
    s_add_u32 s62, s62, s68
    s_add_u32 s63, s61, s67
    s_add_u32 m0, s65, 81920
    s_add_u32 s64, s63, 0
    buffer_load_dwordx4 v11, s[20:23], s64 offen  lds
    s_add_u32 m0, s66, 94208
    s_add_u32 s64, s62, 0
    buffer_load_dwordx4 v10, s[24:27], s64 offen  lds
    s_add_u32 m0, s66, 98304
    s_add_u32 s64, s62, 128
    buffer_load_dwordx4 v10, s[24:27], s64 offen  lds
    s_add_u32 m0, s65, 82944
    s_add_u32 s64, s63, 10240
    buffer_load_dwordx4 v12, s[20:23], s64 offen  lds
    s_add_u32 m0, s66, 102400
    s_add_u32 s64, s62, 256
    buffer_load_dwordx4 v10, s[24:27], s64 offen  lds
    s_add_u32 m0, s65, 83968
    s_add_u32 s64, s63, 20480
    buffer_load_dwordx4 v11, s[20:23], s64 offen  lds
    s_add_u32 m0, s66, 106496
    s_add_u32 s64, s62, 393216
    buffer_load_dwordx4 v10, s[24:27], s64 offen  lds
    s_add_u32 m0, s66, 110592
    s_add_u32 s64, s62, 393344
    buffer_load_dwordx4 v10, s[24:27], s64 offen  lds
    s_add_u32 m0, s66, 114688
    s_add_u32 s64, s62, 393472
    buffer_load_dwordx4 v10, s[24:27], s64 offen  lds
    s_add_u32 s61, s61, 128
    s_cmp_eq_u32 s61, 1280
    s_cselect_b32 s61, 0, s61
    s_add_u32 m0, s6, 128
    s_mov_b64 exec, 1
    buffer_load_dword v16, s[20:23], 0 offen lds
    s_mov_b64 exec, -1
    s_cmp_lg_u32 s14, 8
    s_cbranch_scc1 L_nw8
    s_lshl_b32 s55, s3, 2
    s_add_u32 s55, s55, s60
    s_mul_i32 s55, s55, 7680
    s_mul_i32 s56, s48, 983040
    s_add_u32 s55, s55, s56
    buffer_load_dword v18, v17, s[36:39], s55 offen
L_nw8:
    s_cmp_lg_u32 s15, 8
    s_cbranch_scc1 L_nv8
    s_add_u32 m0, s7, 122880
    s_add_u32 s64, s4, 0
    buffer_load_dwordx4 v14, s[28:31], s64 offen nt lds
    s_add_u32 m0, s7, 129024
    s_add_u32 s64, s4, 128
    buffer_load_dwordx4 v14, s[28:31], s64 offen nt lds
    s_add_u32 m0, s7, 135168
    s_add_u32 s64, s4, 256
    buffer_load_dwordx4 v14, s[28:31], s64 offen nt lds
    s_add_u32 m0, s7, 123904
    s_add_u32 s64, s4, 3072
    buffer_load_dwordx4 v15, s[28:31], s64 offen nt lds
    s_add_u32 m0, s7, 130048
    s_add_u32 s64, s4, 3200
    buffer_load_dwordx4 v15, s[28:31], s64 offen nt lds
    s_add_u32 m0, s7, 136192
    s_add_u32 s64, s4, 3328
    buffer_load_dwordx4 v15, s[28:31], s64 offen nt lds
    s_add_u32 m0, s7, 124928
    s_add_u32 s64, s4, 6144
    buffer_load_dwordx4 v14, s[28:31], s64 offen nt lds
    s_add_u32 m0, s7, 131072
    s_add_u32 s64, s4, 6272
    buffer_load_dwordx4 v14, s[28:31], s64 offen nt lds
    s_add_u32 m0, s7, 137216
    s_add_u32 s64, s4, 6400
    buffer_load_dwordx4 v14, s[28:31], s64 offen nt lds
    s_add_u32 m0, s6, 160
    s_mov_b64 exec, 1
    buffer_load_dword v16, s[20:23], 0 offen lds
    s_mov_b64 exec, -1
L_nv8:
    s_barrier
    s_mul_i32 s62, s61, 6144
    s_add_u32 s62, s62, s68
    s_add_u32 s63, s61, s67
    s_add_u32 m0, s65, 0
    s_add_u32 s64, s63, 0
    buffer_load_dwordx4 v11, s[20:23], s64 offen  lds
    s_add_u32 m0, s66, 12288
    s_add_u32 s64, s62, 0
    buffer_load_dwordx4 v10, s[24:27], s64 offen  lds
    s_add_u32 m0, s66, 16384
    s_add_u32 s64, s62, 128
    buffer_load_dwordx4 v10, s[24:27], s64 offen  lds
    s_add_u32 m0, s65, 1024
    s_add_u32 s64, s63, 10240
    buffer_load_dwordx4 v12, s[20:23], s64 offen  lds
    s_add_u32 m0, s66, 20480
    s_add_u32 s64, s62, 256
    buffer_load_dwordx4 v10, s[24:27], s64 offen  lds
    s_add_u32 m0, s65, 2048
    s_add_u32 s64, s63, 20480
    buffer_load_dwordx4 v11, s[20:23], s64 offen  lds
    s_add_u32 m0, s66, 24576
    s_add_u32 s64, s62, 393216
    buffer_load_dwordx4 v10, s[24:27], s64 offen  lds
    s_add_u32 m0, s66, 28672
    s_add_u32 s64, s62, 393344
    buffer_load_dwordx4 v10, s[24:27], s64 offen  lds
    s_add_u32 m0, s66, 32768
    s_add_u32 s64, s62, 393472
    buffer_load_dwordx4 v10, s[24:27], s64 offen  lds
    s_add_u32 s61, s61, 128
    s_cmp_eq_u32 s61, 1280
    s_cselect_b32 s61, 0, s61
    s_add_u32 m0, s6, 144
    s_mov_b64 exec, 1
    buffer_load_dword v16, s[20:23], 0 offen lds
    s_mov_b64 exec, -1
    s_cmp_lg_u32 s14, 9
    s_cbranch_scc1 L_nw9
    s_lshl_b32 s55, s3, 2
    s_add_u32 s55, s55, s60
    s_mul_i32 s55, s55, 7680
    s_mul_i32 s56, s48, 983040
    s_add_u32 s55, s55, s56
    buffer_load_dword v18, v17, s[36:39], s55 offen
L_nw9:
    s_cmp_lg_u32 s15, 9
    s_cbranch_scc1 L_nv9
    s_add_u32 m0, s7, 122880
    s_add_u32 s64, s4, 0
    buffer_load_dwordx4 v14, s[28:31], s64 offen nt lds
    s_add_u32 m0, s7, 129024
    s_add_u32 s64, s4, 128
    buffer_load_dwordx4 v14, s[28:31], s64 offen nt lds
    s_add_u32 m0, s7, 135168
    s_add_u32 s64, s4, 256
    buffer_load_dwordx4 v14, s[28:31], s64 offen nt lds
    s_add_u32 m0, s7, 123904
    s_add_u32 s64, s4, 3072
    buffer_load_dwordx4 v15, s[28:31], s64 offen nt lds
    s_add_u32 m0, s7, 130048
    s_add_u32 s64, s4, 3200
    buffer_load_dwordx4 v15, s[28:31], s64 offen nt lds
    s_add_u32 m0, s7, 136192
    s_add_u32 s64, s4, 3328
    buffer_load_dwordx4 v15, s[28:31], s64 offen nt lds
    s_add_u32 m0, s7, 124928
    s_add_u32 s64, s4, 6144
    buffer_load_dwordx4 v14, s[28:31], s64 offen nt lds
    s_add_u32 m0, s7, 131072
    s_add_u32 s64, s4, 6272
    buffer_load_dwordx4 v14, s[28:31], s64 offen nt lds
    s_add_u32 m0, s7, 137216
    s_add_u32 s64, s4, 6400
    buffer_load_dwordx4 v14, s[28:31], s64 offen nt lds
    s_add_u32 m0, s6, 160
    s_mov_b64 exec, 1
    buffer_load_dword v16, s[20:23], 0 offen lds
    s_mov_b64 exec, -1
L_nv9:
    s_waitcnt lgkmcnt(0)
    s_add_u32 s59, s59, 0x9e3779b1
    s_barrier
    s_add_u32 s53, s10, 0
    s_and_b32 s53, s53, 3
    s_mul_i32 s62, s53, 245760
    s_add_u32 s62, s62, s9
    s_mul_i32 s63, s53, 18432
    s_add_u32 s63, s63, s5
    s_add_u32 s56, s11, 0
    s_cmp_eq_u32 s56, 3
    s_cselect_b32 s56, 0, s56
    s_mul_i32 s61, s56, 81920
    s_add_u32 s61, s61, s62
    s_lshl_b32 s56, s56, 7
    s_add_u32 s56, s56, s63
    s_add_u32 m0, s65, 40960
    s_add_u32 s64, s56, 0
    buffer_load_dwordx4 v14, s[32:35], s64 offen  lds
    s_add_u32 m0, s8, 53248
    s_nop 0
    buffer_load_dwordx4 v20, s[36:39], s61 offen  lds
    s_add_u32 m0, s8, 54272
    s_nop 0
    buffer_load_dwordx4 v21, s[36:39], s61 offen  lds
    s_add_u32 m0, s65, 41984
    s_add_u32 s64, s56, 3072
    buffer_load_dwordx4 v15, s[32:35], s64 offen  lds
    s_add_u32 m0, s8, 55296
    s_nop 0
    buffer_load_dwordx4 v22, s[36:39], s61 offen  lds
    s_add_u32 m0, s8, 56320
    s_nop 0
    buffer_load_dwordx4 v23, s[36:39], s61 offen  lds
    s_add_u32 m0, s65, 43008
    s_add_u32 s64, s56, 6144
    buffer_load_dwordx4 v14, s[32:35], s64 offen  lds
    s_add_u32 m0, s8, 57344
    s_nop 0
    buffer_load_dwordx4 v24, s[36:39], s61 offen  lds
    s_add_u32 m0, s6, 256
    s_mov_b64 exec, 1
    buffer_load_dword v16, s[20:23], 0 offen lds
    s_mov_b64 exec, -1
    s_barrier
    s_barrier
    s_add_u32 s56, s11, 1
    s_cmp_eq_u32 s56, 3
    s_cselect_b32 s56, 0, s56
    s_mul_i32 s61, s56, 81920
    s_add_u32 s61, s61, s62
    s_lshl_b32 s56, s56, 7
    s_add_u32 s56, s56, s63
    s_add_u32 m0, s65, 0
    s_add_u32 s64, s56, 0
    buffer_load_dwordx4 v14, s[32:35], s64 offen  lds
    s_add_u32 m0, s8, 12288
    s_nop 0
    buffer_load_dwordx4 v20, s[36:39], s61 offen  lds
    s_add_u32 m0, s8, 13312
    s_nop 0
    buffer_load_dwordx4 v21, s[36:39], s61 offen  lds
    s_add_u32 m0, s65, 1024
    s_add_u32 s64, s56, 3072
    buffer_load_dwordx4 v15, s[32:35], s64 offen  lds
    s_add_u32 m0, s8, 14336
    s_nop 0
    buffer_load_dwordx4 v22, s[36:39], s61 offen  lds
    s_add_u32 m0, s8, 15360
    s_nop 0
    buffer_load_dwordx4 v23, s[36:39], s61 offen  lds
    s_add_u32 m0, s65, 2048
    s_add_u32 s64, s56, 6144
    buffer_load_dwordx4 v14, s[32:35], s64 offen  lds
    s_add_u32 m0, s8, 16384
    s_nop 0
    buffer_load_dwordx4 v24, s[36:39], s61 offen  lds
    s_add_u32 m0, s6, 272
    s_mov_b64 exec, 1
    buffer_load_dword v16, s[20:23], 0 offen lds
    s_mov_b64 exec, -1
    s_and_b32 s64, s10, 3
    s_mul_i32 s64, s64, 18432
    s_add_u32 s64, s64, s5
    s_cmp_eq_u32 s11, 0
    s_cselect_b32 s55, 256, 0
    s_add_u32 s64, s64, s55
    buffer_load_dword v18, v28, s[32:35], s64 offen
    s_barrier
    s_barrier
    s_add_u32 s56, s11, 2
    s_cmp_eq_u32 s56, 3
    s_cselect_b32 s56, 0, s56
    s_mul_i32 s61, s56, 81920
    s_add_u32 s61, s61, s62
    s_lshl_b32 s56, s56, 7
    s_add_u32 s56, s56, s63
    s_add_u32 m0, s65, 122880
    s_add_u32 s64, s56, 0
    buffer_load_dwordx4 v14, s[32:35], s64 offen  lds
    s_add_u32 m0, s8, 135168
    s_nop 0
    buffer_load_dwordx4 v20, s[36:39], s61 offen  lds
    s_add_u32 m0, s8, 136192
    s_nop 0
    buffer_load_dwordx4 v21, s[36:39], s61 offen  lds
    s_add_u32 m0, s65, 123904
    s_add_u32 s64, s56, 3072
    buffer_load_dwordx4 v15, s[32:35], s64 offen  lds
    s_add_u32 m0, s8, 137216
    s_nop 0
    buffer_load_dwordx4 v22, s[36:39], s61 offen  lds
    s_add_u32 m0, s8, 138240
    s_nop 0
    buffer_load_dwordx4 v23, s[36:39], s61 offen  lds
    s_add_u32 m0, s65, 124928
    s_add_u32 s64, s56, 6144
    buffer_load_dwordx4 v14, s[32:35], s64 offen  lds
    s_add_u32 m0, s8, 139264
    s_nop 0
    buffer_load_dwordx4 v24, s[36:39], s61 offen  lds
    s_add_u32 m0, s6, 288
    s_mov_b64 exec, 1
    buffer_load_dword v16, s[20:23], 0 offen lds
    s_mov_b64 exec, -1
    s_add_u32 s53, s10, 1
    s_and_b32 s53, s53, 3
    s_mul_i32 s62, s53, 245760
    s_add_u32 s62, s62, s9
    s_mul_i32 s63, s53, 18432
    s_add_u32 s63, s63, s5
    s_add_u32 s56, s11, 0
    s_cmp_eq_u32 s56, 3
    s_cselect_b32 s56, 0, s56
    s_mul_i32 s61, s56, 81920
    s_add_u32 s61, s61, s62
    s_lshl_b32 s56, s56, 7
    s_add_u32 s56, s56, s63
    s_add_u32 m0, s65, 81920
    s_add_u32 s64, s56, 0
    buffer_load_dwordx4 v14, s[32:35], s64 offen  lds
    s_add_u32 m0, s8, 94208
    s_nop 0
    buffer_load_dwordx4 v20, s[36:39], s61 offen  lds
    s_add_u32 m0, s8, 95232
    s_nop 0
    buffer_load_dwordx4 v21, s[36:39], s61 offen  lds
    s_add_u32 m0, s65, 82944
    s_add_u32 s64, s56, 3072
    buffer_load_dwordx4 v15, s[32:35], s64 offen  lds
    s_add_u32 m0, s8, 96256
    s_nop 0
    buffer_load_dwordx4 v22, s[36:39], s61 offen  lds
    s_add_u32 m0, s8, 97280
    s_nop 0
    buffer_load_dwordx4 v23, s[36:39], s61 offen  lds
    s_add_u32 m0, s65, 83968
    s_add_u32 s64, s56, 6144
    buffer_load_dwordx4 v14, s[32:35], s64 offen  lds
    s_add_u32 m0, s8, 98304
    s_nop 0
    buffer_load_dwordx4 v24, s[36:39], s61 offen  lds
    s_add_u32 m0, s6, 304
    s_mov_b64 exec, 1
    buffer_load_dword v16, s[20:23], 0 offen lds
    s_mov_b64 exec, -1
    v_and_b32 v2, 7, v1
    v_lshlrev_b32 v2, 2, v2
    v_lshlrev_b32 v3, 4, v1
    s_barrier
    s_add_u32 s56, s11, 1
    s_cmp_eq_u32 s56, 3
    s_cselect_b32 s56, 0, s56
    s_mul_i32 s61, s56, 81920
    s_add_u32 s61, s61, s62
    s_lshl_b32 s56, s56, 7
    s_add_u32 s56, s56, s63
    s_add_u32 m0, s65, 40960
    s_add_u32 s64, s56, 0
    buffer_load_dwordx4 v14, s[32:35], s64 offen  lds
    s_add_u32 m0, s8, 53248
    s_nop 0
    buffer_load_dwordx4 v20, s[36:39], s61 offen  lds
    s_add_u32 m0, s8, 54272
    s_nop 0
    buffer_load_dwordx4 v21, s[36:39], s61 offen  lds
    s_add_u32 m0, s65, 41984
    s_add_u32 s64, s56, 3072
    buffer_load_dwordx4 v15, s[32:35], s64 offen  lds
    s_add_u32 m0, s8, 55296
    s_nop 0
    buffer_load_dwordx4 v22, s[36:39], s61 offen  lds
    s_add_u32 m0, s8, 56320
    s_nop 0
    buffer_load_dwordx4 v23, s[36:39], s61 offen  lds
    s_add_u32 m0, s65, 43008
    s_add_u32 s64, s56, 6144
    buffer_load_dwordx4 v14, s[32:35], s64 offen  lds
    s_add_u32 m0, s8, 57344
    s_nop 0
    buffer_load_dwordx4 v24, s[36:39], s61 offen  lds
    s_add_u32 m0, s6, 320
    s_mov_b64 exec, 1
    buffer_load_dword v16, s[20:23], 0 offen lds
    s_mov_b64 exec, -1
    s_add_u32 s56, s11, 2
    s_cmp_eq_u32 s56, 3
    s_cselect_b32 s56, 0, s56
    s_mul_i32 s61, s56, 81920
    s_add_u32 s61, s61, s62
    s_lshl_b32 s56, s56, 7
    s_add_u32 s56, s56, s63
    s_add_u32 m0, s65, 0
    s_add_u32 s64, s56, 0
    buffer_load_dwordx4 v14, s[32:35], s64 offen  lds
    s_add_u32 m0, s8, 12288
    s_nop 0
    buffer_load_dwordx4 v20, s[36:39], s61 offen  lds
    s_add_u32 m0, s8, 13312
    s_nop 0
    buffer_load_dwordx4 v21, s[36:39], s61 offen  lds
    s_add_u32 m0, s65, 1024
    s_add_u32 s64, s56, 3072
    buffer_load_dwordx4 v15, s[32:35], s64 offen  lds
    s_add_u32 m0, s8, 14336
    s_nop 0
    buffer_load_dwordx4 v22, s[36:39], s61 offen  lds
    s_add_u32 m0, s8, 15360
    s_nop 0
    buffer_load_dwordx4 v23, s[36:39], s61 offen  lds
    s_add_u32 m0, s65, 2048
    s_add_u32 s64, s56, 6144
    buffer_load_dwordx4 v14, s[32:35], s64 offen  lds
    s_add_u32 m0, s8, 16384
    s_nop 0
    buffer_load_dwordx4 v24, s[36:39], s61 offen  lds
    s_add_u32 m0, s6, 336
    s_mov_b64 exec, 1
    buffer_load_dword v16, s[20:23], 0 offen lds
    s_mov_b64 exec, -1
    s_barrier
    s_add_u32 s53, s10, 2
    s_and_b32 s53, s53, 3
    s_mul_i32 s62, s53, 245760
    s_add_u32 s62, s62, s9
    s_mul_i32 s63, s53, 18432
    s_add_u32 s63, s63, s5
    s_add_u32 s56, s11, 0
    s_cmp_eq_u32 s56, 3
    s_cselect_b32 s56, 0, s56
    s_mul_i32 s61, s56, 81920
    s_add_u32 s61, s61, s62
    s_lshl_b32 s56, s56, 7
    s_add_u32 s56, s56, s63
    s_add_u32 m0, s65, 122880
    s_add_u32 s64, s56, 0
    buffer_load_dwordx4 v14, s[32:35], s64 offen  lds
    s_add_u32 m0, s8, 135168
    s_nop 0
    buffer_load_dwordx4 v20, s[36:39], s61 offen  lds
    s_add_u32 m0, s8, 136192
    s_nop 0
    buffer_load_dwordx4 v21, s[36:39], s61 offen  lds
    s_add_u32 m0, s65, 123904
    s_add_u32 s64, s56, 3072
    buffer_load_dwordx4 v15, s[32:35], s64 offen  lds
    s_add_u32 m0, s8, 137216
    s_nop 0
    buffer_load_dwordx4 v22, s[36:39], s61 offen  lds
    s_add_u32 m0, s8, 138240
    s_nop 0
    buffer_load_dwordx4 v23, s[36:39], s61 offen  lds
    s_add_u32 m0, s65, 124928
    s_add_u32 s64, s56, 6144
    buffer_load_dwordx4 v14, s[32:35], s64 offen  lds
    s_add_u32 m0, s8, 139264
    s_nop 0
    buffer_load_dwordx4 v24, s[36:39], s61 offen  lds
    s_add_u32 m0, s6, 352
    s_mov_b64 exec, 1
    buffer_load_dword v16, s[20:23], 0 offen lds
    s_mov_b64 exec, -1
    s_add_u32 s56, s11, 1
    s_cmp_eq_u32 s56, 3
    s_cselect_b32 s56, 0, s56
    s_mul_i32 s61, s56, 81920
    s_add_u32 s61, s61, s62
    s_lshl_b32 s56, s56, 7
    s_add_u32 s56, s56, s63
    s_add_u32 m0, s65, 81920
    s_add_u32 s64, s56, 0
    buffer_load_dwordx4 v14, s[32:35], s64 offen  lds
    s_add_u32 m0, s8, 94208
    s_nop 0
    buffer_load_dwordx4 v20, s[36:39], s61 offen  lds
    s_add_u32 m0, s8, 95232
    s_nop 0
    buffer_load_dwordx4 v21, s[36:39], s61 offen  lds
    s_add_u32 m0, s65, 82944
    s_add_u32 s64, s56, 3072
    buffer_load_dwordx4 v15, s[32:35], s64 offen  lds
    s_add_u32 m0, s8, 96256
    s_nop 0
    buffer_load_dwordx4 v22, s[36:39], s61 offen  lds
    s_add_u32 m0, s8, 97280
    s_nop 0
    buffer_load_dwordx4 v23, s[36:39], s61 offen  lds
    s_add_u32 m0, s65, 83968
    s_add_u32 s64, s56, 6144
    buffer_load_dwordx4 v14, s[32:35], s64 offen  lds
    s_add_u32 m0, s8, 98304
    s_nop 0
    buffer_load_dwordx4 v24, s[36:39], s61 offen  lds
    s_add_u32 m0, s6, 368
    s_mov_b64 exec, 1
    buffer_load_dword v16, s[20:23], 0 offen lds
    s_mov_b64 exec, -1
    s_barrier
    s_add_u32 s56, s11, 2
    s_cmp_eq_u32 s56, 3
    s_cselect_b32 s56, 0, s56
    s_mul_i32 s61, s56, 81920
    s_add_u32 s61, s61, s62
    s_lshl_b32 s56, s56, 7
    s_add_u32 s56, s56, s63
    s_add_u32 m0, s65, 40960
    s_add_u32 s64, s56, 0
    buffer_load_dwordx4 v14, s[32:35], s64 offen  lds
    s_add_u32 m0, s8, 53248
    s_nop 0
    buffer_load_dwordx4 v20, s[36:39], s61 offen  lds
    s_add_u32 m0, s8, 54272
    s_nop 0
    buffer_load_dwordx4 v21, s[36:39], s61 offen  lds
    s_add_u32 m0, s65, 41984
    s_add_u32 s64, s56, 3072
    buffer_load_dwordx4 v15, s[32:35], s64 offen  lds
    s_add_u32 m0, s8, 55296
    s_nop 0
    buffer_load_dwordx4 v22, s[36:39], s61 offen  lds
    s_add_u32 m0, s8, 56320
    s_nop 0
    buffer_load_dwordx4 v23, s[36:39], s61 offen  lds
    s_add_u32 m0, s65, 43008
    s_add_u32 s64, s56, 6144
    buffer_load_dwordx4 v14, s[32:35], s64 offen  lds
    s_add_u32 m0, s8, 57344
    s_nop 0
    buffer_load_dwordx4 v24, s[36:39], s61 offen  lds
    s_add_u32 m0, s6, 384
    s_mov_b64 exec, 1
    buffer_load_dword v16, s[20:23], 0 offen lds
    s_mov_b64 exec, -1
    s_add_u32 s53, s10, 3
    s_and_b32 s53, s53, 3
    s_mul_i32 s62, s53, 245760
    s_add_u32 s62, s62, s9
    s_mul_i32 s63, s53, 18432
    s_add_u32 s63, s63, s5
    s_add_u32 s56, s11, 0
    s_cmp_eq_u32 s56, 3
    s_cselect_b32 s56, 0, s56
    s_mul_i32 s61, s56, 81920
    s_add_u32 s61, s61, s62
    s_lshl_b32 s56, s56, 7
    s_add_u32 s56, s56, s63
    s_add_u32 m0, s65, 0
    s_add_u32 s64, s56, 0
    buffer_load_dwordx4 v14, s[32:35], s64 offen  lds
    s_add_u32 m0, s8, 12288
    s_nop 0
    buffer_load_dwordx4 v20, s[36:39], s61 offen  lds
    s_add_u32 m0, s8, 13312
    s_nop 0
    buffer_load_dwordx4 v21, s[36:39], s61 offen  lds
    s_add_u32 m0, s65, 1024
    s_add_u32 s64, s56, 3072
    buffer_load_dwordx4 v15, s[32:35], s64 offen  lds
    s_add_u32 m0, s8, 14336
    s_nop 0
    buffer_load_dwordx4 v22, s[36:39], s61 offen  lds
    s_add_u32 m0, s8, 15360
    s_nop 0
    buffer_load_dwordx4 v23, s[36:39], s61 offen  lds
    s_add_u32 m0, s65, 2048
    s_add_u32 s64, s56, 6144
    buffer_load_dwordx4 v14, s[32:35], s64 offen  lds
    s_add_u32 m0, s8, 16384
    s_nop 0
    buffer_load_dwordx4 v24, s[36:39], s61 offen  lds
    s_add_u32 m0, s6, 400
    s_mov_b64 exec, 1
    buffer_load_dword v16, s[20:23], 0 offen lds
    s_mov_b64 exec, -1
    s_barrier
    s_add_u32 s56, s11, 1
    s_cmp_eq_u32 s56, 3
    s_cselect_b32 s56, 0, s56
    s_mul_i32 s61, s56, 81920
    s_add_u32 s61, s61, s62
    s_lshl_b32 s56, s56, 7
    s_add_u32 s56, s56, s63
    s_add_u32 m0, s65, 122880
    s_add_u32 s64, s56, 0
    buffer_load_dwordx4 v14, s[32:35], s64 offen  lds
    s_add_u32 m0, s8, 135168
    s_nop 0
    buffer_load_dwordx4 v20, s[36:39], s61 offen  lds
    s_add_u32 m0, s8, 136192
    s_nop 0
    buffer_load_dwordx4 v21, s[36:39], s61 offen  lds
    s_add_u32 m0, s65, 123904
    s_add_u32 s64, s56, 3072
    buffer_load_dwordx4 v15, s[32:35], s64 offen  lds
    s_add_u32 m0, s8, 137216
    s_nop 0
    buffer_load_dwordx4 v22, s[36:39], s61 offen  lds
    s_add_u32 m0, s8, 138240
    s_nop 0
    buffer_load_dwordx4 v23, s[36:39], s61 offen  lds
    s_add_u32 m0, s65, 124928
    s_add_u32 s64, s56, 6144
    buffer_load_dwordx4 v14, s[32:35], s64 offen  lds
    s_add_u32 m0, s8, 139264
    s_nop 0
    buffer_load_dwordx4 v24, s[36:39], s61 offen  lds
    s_add_u32 m0, s6, 416
    s_mov_b64 exec, 1
    buffer_load_dword v16, s[20:23], 0 offen lds
    s_mov_b64 exec, -1
    s_barrier
    buffer_load_dword v4, v2, s[44:47], s12 offen sc1
    s_add_u32 s56, s11, 2
    s_cmp_eq_u32 s56, 3
    s_cselect_b32 s56, 0, s56
    s_mul_i32 s61, s56, 81920
    s_add_u32 s61, s61, s62
    s_lshl_b32 s56, s56, 7
    s_add_u32 s56, s56, s63
    s_add_u32 m0, s65, 81920
    s_add_u32 s64, s56, 0
    buffer_load_dwordx4 v14, s[32:35], s64 offen  lds
    s_add_u32 m0, s8, 94208
    s_nop 0
    buffer_load_dwordx4 v20, s[36:39], s61 offen  lds
    s_add_u32 m0, s8, 95232
    s_nop 0
    buffer_load_dwordx4 v21, s[36:39], s61 offen  lds
    s_add_u32 m0, s65, 82944
    s_add_u32 s64, s56, 3072
    buffer_load_dwordx4 v15, s[32:35], s64 offen  lds
    s_add_u32 m0, s8, 96256
    s_nop 0
    buffer_load_dwordx4 v22, s[36:39], s61 offen  lds
    s_add_u32 m0, s8, 97280
    s_nop 0
    buffer_load_dwordx4 v23, s[36:39], s61 offen  lds
    s_add_u32 m0, s65, 83968
    s_add_u32 s64, s56, 6144
    buffer_load_dwordx4 v14, s[32:35], s64 offen  lds
    s_add_u32 m0, s8, 98304
    s_nop 0
    buffer_load_dwordx4 v24, s[36:39], s61 offen  lds
    s_add_u32 m0, s6, 432
    s_mov_b64 exec, 1
    buffer_load_dword v16, s[20:23], 0 offen lds
    s_mov_b64 exec, -1
    s_barrier
    s_mov_b32 s55, 0
    s_waitcnt vmcnt(9)
    v_cmp_ne_u32 vcc, s59, v4
    s_cbranch_vccz L_lpolld
L_lpoll:
    buffer_load_dword v4, v2, s[44:47], s12 offen sc1
    s_add_u32 s55, s55, 1
    s_cmp_ge_u32 s55, 100000
    s_cbranch_scc1 L_lpolld
    s_waitcnt vmcnt(0)
    v_cmp_ne_u32 vcc, s59, v4
    s_cbranch_vccz L_lpolld
    s_sleep 1
    s_branch L_lpoll
L_lpolld:
    s_mul_i32 s56, s60, 9216
    s_lshl_b32 s53, s54, 1
    s_add_u32 s53, s53, 0
    s_add_u32 s53, s53, s10
    s_and_b32 s53, s53, 3
    s_mul_i32 s53, s53, 5120
    s_add_u32 s53, s53, s13
    s_add_u32 m0, s56, 40960
    s_add_u32 s64, s53, 0
    buffer_load_dwordx4 v3, s[44:47], s64 offen sc1 lds
    s_add_u32 m0, s56, 41984
    s_add_u32 s64, s53, 1024
    buffer_load_dwordx4 v3, s[44:47], s64 offen sc1 lds
    s_add_u32 m0, s56, 43008
    s_add_u32 s64, s53, 2048
    buffer_load_dwordx4 v3, s[44:47], s64 offen sc1 lds
    s_add_u32 m0, s56, 44032
    s_add_u32 s64, s53, 3072
    buffer_load_dwordx4 v3, s[44:47], s64 offen sc1 lds
    s_mov_b32 exec_hi, 0
    s_add_u32 m0, s56, 45056
    s_add_u32 s64, s53, 4096
    buffer_load_dwordx4 v3, s[44:47], s64 offen sc1 lds
    s_mov_b64 exec, -1
    s_lshl_b32 s53, s54, 1
    s_add_u32 s53, s53, 1
    s_add_u32 s53, s53, s10
    s_and_b32 s53, s53, 3
    s_mul_i32 s53, s53, 5120
    s_add_u32 s53, s53, s13
    s_add_u32 m0, s56, 45568
    s_add_u32 s64, s53, 0
    buffer_load_dwordx4 v3, s[44:47], s64 offen sc1 lds
    s_add_u32 m0, s56, 46592
    s_add_u32 s64, s53, 1024
    buffer_load_dwordx4 v3, s[44:47], s64 offen sc1 lds
    s_add_u32 m0, s56, 47616
    s_add_u32 s64, s53, 2048
    buffer_load_dwordx4 v3, s[44:47], s64 offen sc1 lds
    s_add_u32 m0, s56, 48640
    s_add_u32 s64, s53, 3072
    buffer_load_dwordx4 v3, s[44:47], s64 offen sc1 lds
    s_mov_b32 exec_hi, 0
    s_add_u32 m0, s56, 49664
    s_add_u32 s64, s53, 4096
    buffer_load_dwordx4 v3, s[44:47], s64 offen sc1 lds
    s_mov_b64 exec, -1
    s_add_u32 m0, s6, 480
    s_mov_b64 exec, 1
    buffer_load_dword v16, s[20:23], 0 offen lds
    s_mov_b64 exec, -1
    s_waitcnt vmcnt(0)
    s_endpgm
L_compute:
    s_setprio 2
    v_lshlrev_b32 v10, 4, v1
    v_lshlrev_b32 v2, 2, v0
    v_add_u32 v2, 36864, v2
    v_mov_b32 v4, 1
    ds_write_b32 v2, v4
    s_getpc_b64 s[60:61]
L_pc:
    s_sub_u32 s60, s60, L_pc-standalone__mha_block_cached__near_ridge_kernel
    s_subb_u32 s61, s61, 0
    s_lshl_b32 s53, s3, 10
    v_and_b32 v2, 7, v1
    v_lshlrev_b32 v2, 7, v2
    v_add_u32 v2, s53, v2
    global_load_dword v191, v2, s[60:61]
    s_waitcnt lgkmcnt(0)
    s_barrier
    s_lshl_b32 s55, s50, 7
    s_add_u32 s55, s55, 3276800
    s_load_dword s59, s[18:19], s55
    s_mov_b32 s40, s14
    s_mov_b32 s41, s15
    s_mov_b32 s42, 983040
    s_mov_b32 s43, 0x00020000
    s_mov_b32 s44, s18
    s_mov_b32 s45, s19
    s_mov_b32 s46, 268435456
    s_mov_b32 s47, 0x00020000
    s_mov_b32 s17, 0
    s_lshr_b32 s60, s52, 1
    s_and_b32 s61, s52, 1
    v_lshlrev_b32 v13, 3, v1
    v_add_u32 v13, 512, v13
    v_lshrrev_b32 v2, 4, v1
    v_and_b32 v3, 15, v1
    v_mul_u32_u24 v4, 1280, v3
    v_lshl_add_u32 v12, v2, 3, v4
    v_and_b32 v4, 7, v1
    v_lshlrev_b32 v11, 2, v4
    v_and_b32 v4, 3, v1
    v_lshlrev_b32 v5, 2, v4
    v_add_u32 v14, 36864, v5
    s_xor_b32 s56, s52, 1
    s_mul_i32 s55, s52, 9216
    s_mul_i32 s54, s56, 9216
    s_add_u32 s55, s55, 81920
    s_add_u32 s54, s54, 81920
    v_add_u32 v180, s55, v10
    v_add_u32 v181, s54, v10
    v_lshrrev_b32 v8, 1, v3
    v_xor_b32 v4, v8, v2
    v_lshlrev_b32 v4, 4, v4
    v_lshl_add_u32 v4, v3, 7, v4
    s_mul_i32 s55, s60, 6144
    v_add_u32 v22, s55, v4
    v_xor_b32 v23, 64, v22
    v_add_u32 v30, 81920, v22
    v_add_u32 v31, 81920, v23
    v_lshrrev_b32 v9, 1, v2
    v_xor_b32 v9, v9, v8
    v_and_b32 v4, 1, v2
    v_lshlrev_b32 v4, 3, v4
    v_lshl_add_u32 v4, v3, 7, v4
    s_mul_i32 s55, s61, 12
    s_mul_i32 s54, s60, 18432
    s_add_u32 s54, s54, 122880
    s_add_u32 s56, s55, 0
    s_and_b32 s53, s56, 7
    s_lshr_b32 s56, s56, 3
    s_mul_i32 s56, s56, 6144
    s_add_u32 s56, s56, s54
    v_xor_b32 v6, s53, v9
    v_lshl_add_u32 v6, v6, 4, v4
    v_add_u32 v182, s56, v6
    s_add_u32 s56, s55, 2
    s_and_b32 s53, s56, 7
    s_lshr_b32 s56, s56, 3
    s_mul_i32 s56, s56, 6144
    s_add_u32 s56, s56, s54
    v_xor_b32 v6, s53, v9
    v_lshl_add_u32 v6, v6, 4, v4
    v_add_u32 v183, s56, v6
    s_add_u32 s56, s55, 4
    s_and_b32 s53, s56, 7
    s_lshr_b32 s56, s56, 3
    s_mul_i32 s56, s56, 6144
    s_add_u32 s56, s56, s54
    v_xor_b32 v6, s53, v9
    v_lshl_add_u32 v6, v6, 4, v4
    v_add_u32 v184, s56, v6
    s_add_u32 s56, s55, 6
    s_and_b32 s53, s56, 7
    s_lshr_b32 s56, s56, 3
    s_mul_i32 s56, s56, 6144
    s_add_u32 s56, s56, s54
    v_xor_b32 v6, s53, v9
    v_lshl_add_u32 v6, v6, 4, v4
    v_add_u32 v185, s56, v6
    s_add_u32 s56, s55, 8
    s_and_b32 s53, s56, 7
    s_lshr_b32 s56, s56, 3
    s_mul_i32 s56, s56, 6144
    s_add_u32 s56, s56, s54
    v_xor_b32 v6, s53, v9
    v_lshl_add_u32 v6, v6, 4, v4
    v_add_u32 v186, s56, v6
    s_add_u32 s56, s55, 10
    s_and_b32 s53, s56, 7
    s_lshr_b32 s56, s56, 3
    s_mul_i32 s56, s56, 6144
    s_add_u32 s56, s56, s54
    v_xor_b32 v6, s53, v9
    v_lshl_add_u32 v6, v6, 4, v4
    v_add_u32 v187, s56, v6
    v_lshrrev_b32 v4, 2, v1
    v_and_b32 v4, 7, v4
    v_lshrrev_b32 v5, 5, v1
    v_lshlrev_b32 v5, 11, v5
    v_lshl_add_u32 v5, v4, 7, v5
    v_and_b32 v6, 3, v1
    v_lshl_add_u32 v5, v6, 3, v5
    v_lshrrev_b32 v4, 1, v4
    s_mul_i32 s55, s61, 6
    s_add_u32 s56, s55, 0
    s_and_b32 s53, s56, 3
    s_lshr_b32 s56, s56, 2
    s_lshl_b32 s56, s56, 12
    s_add_u32 s56, s56, 12288
    v_xor_b32 v6, s53, v4
    v_lshl_add_u32 v6, v6, 5, v5
    v_add_u32 v16, s56, v6
    v_add_u32 v24, 81920, v16
    s_add_u32 s56, s55, 1
    s_and_b32 s53, s56, 3
    s_lshr_b32 s56, s56, 2
    s_lshl_b32 s56, s56, 12
    s_add_u32 s56, s56, 12288
    v_xor_b32 v6, s53, v4
    v_lshl_add_u32 v6, v6, 5, v5
    v_add_u32 v17, s56, v6
    v_add_u32 v25, 81920, v17
    s_add_u32 s56, s55, 2
    s_and_b32 s53, s56, 3
    s_lshr_b32 s56, s56, 2
    s_lshl_b32 s56, s56, 12
    s_add_u32 s56, s56, 12288
    v_xor_b32 v6, s53, v4
    v_lshl_add_u32 v6, v6, 5, v5
    v_add_u32 v18, s56, v6
    v_add_u32 v26, 81920, v18
    s_add_u32 s56, s55, 3
    s_and_b32 s53, s56, 3
    s_lshr_b32 s56, s56, 2
    s_lshl_b32 s56, s56, 12
    s_add_u32 s56, s56, 12288
    v_xor_b32 v6, s53, v4
    v_lshl_add_u32 v6, v6, 5, v5
    v_add_u32 v19, s56, v6
    v_add_u32 v27, 81920, v19
    s_add_u32 s56, s55, 4
    s_and_b32 s53, s56, 3
    s_lshr_b32 s56, s56, 2
    s_lshl_b32 s56, s56, 12
    s_add_u32 s56, s56, 12288
    v_xor_b32 v6, s53, v4
    v_lshl_add_u32 v6, v6, 5, v5
    v_add_u32 v20, s56, v6
    v_add_u32 v28, 81920, v20
    s_add_u32 s56, s55, 5
    s_and_b32 s53, s56, 3
    s_lshr_b32 s56, s56, 2
    s_lshl_b32 s56, s56, 12
    s_add_u32 s56, s56, 12288
    v_xor_b32 v6, s53, v4
    v_lshl_add_u32 v6, v6, 5, v5
    v_add_u32 v21, s56, v6
    v_add_u32 v29, 81920, v21
    s_lshl_b32 s55, s50, 1
    s_add_u32 s55, s55, s60
    s_mul_i32 s69, s55, 61440
    s_lshl_b32 s55, s55, 3
    s_add_u32 s55, s55, s48
    s_mul_i32 s62, s55, 20480
    s_mul_i32 s56, s49, 5120
    s_add_u32 s66, s62, s56
    s_lshl_b32 s65, s55, 7
    s_add_u32 s65, s65, 3145728
    s_mul_i32 s56, s49, 320
    s_add_u32 s69, s69, s56
    s_mul_i32 s56, s61, 160
    s_add_u32 s69, s69, s56
    v_lshrrev_b32 v2, 4, v1
    v_lshrrev_b32 v3, 2, v1
    v_and_b32 v3, 3, v3
    v_lshl_add_u32 v3, v2, 3, v3
    v_mul_u32_u24 v3, 320, v3
    v_and_b32 v4, 3, v1
    v_lshl_add_u32 v3, v4, 3, v3
    v_and_b32 v2, 1, v2
    v_lshlrev_b32 v2, 5, v2
    v_add_u32 v4, v3, v2
    v_sub_u32 v5, v3, v2
    s_add_u32 s56, s56, 12288
    s_cmp_eq_u32 s61, 0
    s_cselect_b64 vcc, -1, 0
    v_cndmask_b32 v6, v5, v4, vcc
    v_cndmask_b32 v7, v4, v5, vcc
    v_add_u32 v176, s56, v6
    v_add_u32 v178, s56, v7
    v_add_u32 v177, 81920, v176
    v_add_u32 v179, 81920, v178
    s_mov_b32 s57, 0x3dd53b95
    s_waitcnt lgkmcnt(0)
    s_add_u32 s59, s59, 0x9e3779b1
    v_mov_b32 v189, s59
    s_lshl_b32 s53, s49, 1
    s_add_u32 s53, s53, s61
    s_lshl_b32 s53, s53, 2
    v_mov_b32 v190, s53
    s_branch L_slow0
L_cont0:
    ds_read_b128 v[56:59], v22 offset:40960
    ds_read_b64_tr_b16 v[32:33], v16 offset:40960
    ds_read_b64_tr_b16 v[34:35], v16 offset:41984
    ds_read_b128 v[60:63], v22 offset:43008
    ds_read_b128 v[64:67], v22 offset:45056
    ds_read_b64_tr_b16 v[36:37], v17 offset:40960
    ds_read_b64_tr_b16 v[38:39], v17 offset:41984
    ds_read_b64_tr_b16 v[40:41], v18 offset:40960
    ds_read_b64_tr_b16 v[42:43], v18 offset:41984
    ds_read_b64_tr_b16 v[44:45], v19 offset:40960
    ds_read_b64_tr_b16 v[46:47], v19 offset:41984
    ds_read_b64_tr_b16 v[48:49], v20 offset:40960
    ds_read_b64_tr_b16 v[50:51], v20 offset:41984
    ds_read_b64_tr_b16 v[52:53], v21 offset:40960
    ds_read_b64_tr_b16 v[54:55], v21 offset:41984
    s_waitcnt lgkmcnt(0)
    v_mfma_f32_16x16x32_bf16 v[104:107], v[32:35], v[56:59], 0
    ds_read_b128 v[92:95], v23 offset:40960
    ds_read_b64_tr_b16 v[68:69], v16 offset:53248
    v_mfma_f32_16x16x32_bf16 v[108:111], v[32:35], v[60:63], 0
    ds_read_b64_tr_b16 v[70:71], v16 offset:54272
    ds_read_b128 v[96:99], v23 offset:43008
    v_mfma_f32_16x16x32_bf16 v[112:115], v[32:35], v[64:67], 0
    ds_read_b128 v[100:103], v23 offset:45056
    ds_read_b64_tr_b16 v[72:73], v17 offset:53248
    v_mfma_f32_16x16x32_bf16 v[116:119], v[36:39], v[56:59], 0
    ds_read_b64_tr_b16 v[74:75], v17 offset:54272
    ds_read_b64_tr_b16 v[76:77], v18 offset:53248
    v_mfma_f32_16x16x32_bf16 v[120:123], v[36:39], v[60:63], 0
    ds_read_b64_tr_b16 v[78:79], v18 offset:54272
    v_mfma_f32_16x16x32_bf16 v[124:127], v[36:39], v[64:67], 0
    ds_read_b64_tr_b16 v[80:81], v19 offset:53248
    v_mfma_f32_16x16x32_bf16 v[128:131], v[40:43], v[56:59], 0
    ds_read_b64_tr_b16 v[82:83], v19 offset:54272
    v_mfma_f32_16x16x32_bf16 v[132:135], v[40:43], v[60:63], 0
    ds_read_b64_tr_b16 v[84:85], v20 offset:53248
    v_mfma_f32_16x16x32_bf16 v[136:139], v[40:43], v[64:67], 0
    ds_read_b64_tr_b16 v[86:87], v20 offset:54272
    v_mfma_f32_16x16x32_bf16 v[140:143], v[44:47], v[56:59], 0
    ds_read_b64_tr_b16 v[88:89], v21 offset:53248
    v_mfma_f32_16x16x32_bf16 v[144:147], v[44:47], v[60:63], 0
    ds_read_b64_tr_b16 v[90:91], v21 offset:54272
    v_mfma_f32_16x16x32_bf16 v[148:151], v[44:47], v[64:67], 0
    ds_read_b32 v15, v14 offset:16
    v_mfma_f32_16x16x32_bf16 v[152:155], v[48:51], v[56:59], 0
    v_mfma_f32_16x16x32_bf16 v[156:159], v[48:51], v[60:63], 0
    v_mfma_f32_16x16x32_bf16 v[160:163], v[48:51], v[64:67], 0
    v_mfma_f32_16x16x32_bf16 v[164:167], v[52:55], v[56:59], 0
    v_mfma_f32_16x16x32_bf16 v[168:171], v[52:55], v[60:63], 0
    v_mfma_f32_16x16x32_bf16 v[172:175], v[52:55], v[64:67], 0
    s_waitcnt lgkmcnt(0)
    v_cmp_ne_u32 vcc, 0, v15
    v_mfma_f32_16x16x32_bf16 v[104:107], v[68:71], v[92:95], v[104:107]
    s_cbranch_vccnz L_slow1
L_cont1:
    v_mfma_f32_16x16x32_bf16 v[108:111], v[68:71], v[96:99], v[108:111]
    ds_read_b128 v[56:59], v30 offset:0
    ds_read_b64_tr_b16 v[32:33], v24 offset:0
    v_mfma_f32_16x16x32_bf16 v[112:115], v[68:71], v[100:103], v[112:115]
    ds_read_b64_tr_b16 v[34:35], v24 offset:1024
    ds_read_b128 v[60:63], v30 offset:2048
    v_mfma_f32_16x16x32_bf16 v[116:119], v[72:75], v[92:95], v[116:119]
    ds_read_b128 v[64:67], v30 offset:4096
    ds_read_b64_tr_b16 v[36:37], v25 offset:0
    v_mfma_f32_16x16x32_bf16 v[120:123], v[72:75], v[96:99], v[120:123]
    ds_read_b64_tr_b16 v[38:39], v25 offset:1024
    ds_read_b64_tr_b16 v[40:41], v26 offset:0
    v_mfma_f32_16x16x32_bf16 v[124:127], v[72:75], v[100:103], v[124:127]
    ds_read_b64_tr_b16 v[42:43], v26 offset:1024
    v_mfma_f32_16x16x32_bf16 v[128:131], v[76:79], v[92:95], v[128:131]
    ds_read_b64_tr_b16 v[44:45], v27 offset:0
    v_mfma_f32_16x16x32_bf16 v[132:135], v[76:79], v[96:99], v[132:135]
    ds_read_b64_tr_b16 v[46:47], v27 offset:1024
    v_mfma_f32_16x16x32_bf16 v[136:139], v[76:79], v[100:103], v[136:139]
    ds_read_b64_tr_b16 v[48:49], v28 offset:0
    v_mfma_f32_16x16x32_bf16 v[140:143], v[80:83], v[92:95], v[140:143]
    ds_read_b64_tr_b16 v[50:51], v28 offset:1024
    v_mfma_f32_16x16x32_bf16 v[144:147], v[80:83], v[96:99], v[144:147]
    ds_read_b64_tr_b16 v[52:53], v29 offset:0
    v_mfma_f32_16x16x32_bf16 v[148:151], v[80:83], v[100:103], v[148:151]
    ds_read_b64_tr_b16 v[54:55], v29 offset:1024
    v_mfma_f32_16x16x32_bf16 v[152:155], v[84:87], v[92:95], v[152:155]
    v_mfma_f32_16x16x32_bf16 v[156:159], v[84:87], v[96:99], v[156:159]
    v_mfma_f32_16x16x32_bf16 v[160:163], v[84:87], v[100:103], v[160:163]
    v_mfma_f32_16x16x32_bf16 v[164:167], v[88:91], v[92:95], v[164:167]
    v_mfma_f32_16x16x32_bf16 v[168:171], v[88:91], v[96:99], v[168:171]
    v_mfma_f32_16x16x32_bf16 v[172:175], v[88:91], v[100:103], v[172:175]
    s_waitcnt lgkmcnt(0)
    v_mfma_f32_16x16x32_bf16 v[104:107], v[32:35], v[56:59], v[104:107]
    ds_read_b128 v[92:95], v31 offset:0
    ds_read_b64_tr_b16 v[68:69], v24 offset:12288
    v_mfma_f32_16x16x32_bf16 v[108:111], v[32:35], v[60:63], v[108:111]
    ds_read_b64_tr_b16 v[70:71], v24 offset:13312
    ds_read_b128 v[96:99], v31 offset:2048
    v_mfma_f32_16x16x32_bf16 v[112:115], v[32:35], v[64:67], v[112:115]
    ds_read_b128 v[100:103], v31 offset:4096
    ds_read_b64_tr_b16 v[72:73], v25 offset:12288
    v_mfma_f32_16x16x32_bf16 v[116:119], v[36:39], v[56:59], v[116:119]
    ds_read_b64_tr_b16 v[74:75], v25 offset:13312
    ds_read_b64_tr_b16 v[76:77], v26 offset:12288
    v_mfma_f32_16x16x32_bf16 v[120:123], v[36:39], v[60:63], v[120:123]
    ds_read_b64_tr_b16 v[78:79], v26 offset:13312
    v_mfma_f32_16x16x32_bf16 v[124:127], v[36:39], v[64:67], v[124:127]
    ds_read_b64_tr_b16 v[80:81], v27 offset:12288
    v_mfma_f32_16x16x32_bf16 v[128:131], v[40:43], v[56:59], v[128:131]
    ds_read_b64_tr_b16 v[82:83], v27 offset:13312
    v_mfma_f32_16x16x32_bf16 v[132:135], v[40:43], v[60:63], v[132:135]
    ds_read_b64_tr_b16 v[84:85], v28 offset:12288
    v_mfma_f32_16x16x32_bf16 v[136:139], v[40:43], v[64:67], v[136:139]
    ds_read_b64_tr_b16 v[86:87], v28 offset:13312
    v_mfma_f32_16x16x32_bf16 v[140:143], v[44:47], v[56:59], v[140:143]
    ds_read_b64_tr_b16 v[88:89], v29 offset:12288
    v_mfma_f32_16x16x32_bf16 v[144:147], v[44:47], v[60:63], v[144:147]
    ds_read_b64_tr_b16 v[90:91], v29 offset:13312
    v_mfma_f32_16x16x32_bf16 v[148:151], v[44:47], v[64:67], v[148:151]
    ds_read_b32 v15, v14 offset:32
    v_mfma_f32_16x16x32_bf16 v[152:155], v[48:51], v[56:59], v[152:155]
    v_mfma_f32_16x16x32_bf16 v[156:159], v[48:51], v[60:63], v[156:159]
    v_mfma_f32_16x16x32_bf16 v[160:163], v[48:51], v[64:67], v[160:163]
    v_mfma_f32_16x16x32_bf16 v[164:167], v[52:55], v[56:59], v[164:167]
    v_mfma_f32_16x16x32_bf16 v[168:171], v[52:55], v[60:63], v[168:171]
    v_mfma_f32_16x16x32_bf16 v[172:175], v[52:55], v[64:67], v[172:175]
    s_waitcnt lgkmcnt(0)
    v_cmp_ne_u32 vcc, 0, v15
    v_mfma_f32_16x16x32_bf16 v[104:107], v[68:71], v[92:95], v[104:107]
    s_barrier
    s_cbranch_vccnz L_slow2
L_cont2:
    v_mfma_f32_16x16x32_bf16 v[108:111], v[68:71], v[96:99], v[108:111]
    ds_read_b128 v[56:59], v30 offset:40960
    ds_read_b64_tr_b16 v[32:33], v24 offset:40960
    v_mfma_f32_16x16x32_bf16 v[112:115], v[68:71], v[100:103], v[112:115]
    ds_read_b64_tr_b16 v[34:35], v24 offset:41984
    ds_read_b128 v[60:63], v30 offset:43008
    v_mfma_f32_16x16x32_bf16 v[116:119], v[72:75], v[92:95], v[116:119]
    ds_read_b128 v[64:67], v30 offset:45056
    ds_read_b64_tr_b16 v[36:37], v25 offset:40960
    v_mfma_f32_16x16x32_bf16 v[120:123], v[72:75], v[96:99], v[120:123]
    ds_read_b64_tr_b16 v[38:39], v25 offset:41984
    ds_read_b64_tr_b16 v[40:41], v26 offset:40960
    v_mfma_f32_16x16x32_bf16 v[124:127], v[72:75], v[100:103], v[124:127]
    ds_read_b64_tr_b16 v[42:43], v26 offset:41984
    v_mfma_f32_16x16x32_bf16 v[128:131], v[76:79], v[92:95], v[128:131]
    ds_read_b64_tr_b16 v[44:45], v27 offset:40960
    v_mfma_f32_16x16x32_bf16 v[132:135], v[76:79], v[96:99], v[132:135]
    ds_read_b64_tr_b16 v[46:47], v27 offset:41984
    v_mfma_f32_16x16x32_bf16 v[136:139], v[76:79], v[100:103], v[136:139]
    ds_read_b64_tr_b16 v[48:49], v28 offset:40960
    v_mfma_f32_16x16x32_bf16 v[140:143], v[80:83], v[92:95], v[140:143]
    ds_read_b64_tr_b16 v[50:51], v28 offset:41984
    v_mfma_f32_16x16x32_bf16 v[144:147], v[80:83], v[96:99], v[144:147]
    ds_read_b64_tr_b16 v[52:53], v29 offset:40960
    v_mfma_f32_16x16x32_bf16 v[148:151], v[80:83], v[100:103], v[148:151]
    ds_read_b64_tr_b16 v[54:55], v29 offset:41984
    v_mfma_f32_16x16x32_bf16 v[152:155], v[84:87], v[92:95], v[152:155]
    v_mfma_f32_16x16x32_bf16 v[156:159], v[84:87], v[96:99], v[156:159]
    v_mfma_f32_16x16x32_bf16 v[160:163], v[84:87], v[100:103], v[160:163]
    v_mfma_f32_16x16x32_bf16 v[164:167], v[88:91], v[92:95], v[164:167]
    v_mfma_f32_16x16x32_bf16 v[168:171], v[88:91], v[96:99], v[168:171]
    v_mfma_f32_16x16x32_bf16 v[172:175], v[88:91], v[100:103], v[172:175]
    s_waitcnt lgkmcnt(0)
    v_mfma_f32_16x16x32_bf16 v[104:107], v[32:35], v[56:59], v[104:107]
    ds_read_b128 v[92:95], v31 offset:40960
    ds_read_b64_tr_b16 v[68:69], v24 offset:53248
    v_mfma_f32_16x16x32_bf16 v[108:111], v[32:35], v[60:63], v[108:111]
    ds_read_b64_tr_b16 v[70:71], v24 offset:54272
    ds_read_b128 v[96:99], v31 offset:43008
    v_mfma_f32_16x16x32_bf16 v[112:115], v[32:35], v[64:67], v[112:115]
    ds_read_b128 v[100:103], v31 offset:45056
    ds_read_b64_tr_b16 v[72:73], v25 offset:53248
    v_mfma_f32_16x16x32_bf16 v[116:119], v[36:39], v[56:59], v[116:119]
    ds_read_b64_tr_b16 v[74:75], v25 offset:54272
    ds_read_b64_tr_b16 v[76:77], v26 offset:53248
    v_mfma_f32_16x16x32_bf16 v[120:123], v[36:39], v[60:63], v[120:123]
    ds_read_b64_tr_b16 v[78:79], v26 offset:54272
    v_mfma_f32_16x16x32_bf16 v[124:127], v[36:39], v[64:67], v[124:127]
    ds_read_b64_tr_b16 v[80:81], v27 offset:53248
    v_mfma_f32_16x16x32_bf16 v[128:131], v[40:43], v[56:59], v[128:131]
    ds_read_b64_tr_b16 v[82:83], v27 offset:54272
    v_mfma_f32_16x16x32_bf16 v[132:135], v[40:43], v[60:63], v[132:135]
    ds_read_b64_tr_b16 v[84:85], v28 offset:53248
    v_mfma_f32_16x16x32_bf16 v[136:139], v[40:43], v[64:67], v[136:139]
    ds_read_b64_tr_b16 v[86:87], v28 offset:54272
    v_mfma_f32_16x16x32_bf16 v[140:143], v[44:47], v[56:59], v[140:143]
    ds_read_b64_tr_b16 v[88:89], v29 offset:53248
    v_mfma_f32_16x16x32_bf16 v[144:147], v[44:47], v[60:63], v[144:147]
    ds_read_b64_tr_b16 v[90:91], v29 offset:54272
    v_mfma_f32_16x16x32_bf16 v[148:151], v[44:47], v[64:67], v[148:151]
    ds_read_b32 v15, v14 offset:48
    v_mfma_f32_16x16x32_bf16 v[152:155], v[48:51], v[56:59], v[152:155]
    v_mfma_f32_16x16x32_bf16 v[156:159], v[48:51], v[60:63], v[156:159]
    v_mfma_f32_16x16x32_bf16 v[160:163], v[48:51], v[64:67], v[160:163]
    v_mfma_f32_16x16x32_bf16 v[164:167], v[52:55], v[56:59], v[164:167]
    v_mfma_f32_16x16x32_bf16 v[168:171], v[52:55], v[60:63], v[168:171]
    v_mfma_f32_16x16x32_bf16 v[172:175], v[52:55], v[64:67], v[172:175]
    s_waitcnt lgkmcnt(0)
    v_cmp_ne_u32 vcc, 0, v15
    v_mfma_f32_16x16x32_bf16 v[104:107], v[68:71], v[92:95], v[104:107]
    s_cbranch_vccnz L_slow3
L_cont3:
    v_mfma_f32_16x16x32_bf16 v[108:111], v[68:71], v[96:99], v[108:111]
    ds_read_b128 v[56:59], v22 offset:0
    ds_read_b64_tr_b16 v[32:33], v16 offset:0
    v_mfma_f32_16x16x32_bf16 v[112:115], v[68:71], v[100:103], v[112:115]
    ds_read_b64_tr_b16 v[34:35], v16 offset:1024
    ds_read_b128 v[60:63], v22 offset:2048
    v_mfma_f32_16x16x32_bf16 v[116:119], v[72:75], v[92:95], v[116:119]
    ds_read_b128 v[64:67], v22 offset:4096
    ds_read_b64_tr_b16 v[36:37], v17 offset:0
    v_mfma_f32_16x16x32_bf16 v[120:123], v[72:75], v[96:99], v[120:123]
    ds_read_b64_tr_b16 v[38:39], v17 offset:1024
    ds_read_b64_tr_b16 v[40:41], v18 offset:0
    v_mfma_f32_16x16x32_bf16 v[124:127], v[72:75], v[100:103], v[124:127]
    ds_read_b64_tr_b16 v[42:43], v18 offset:1024
    v_mfma_f32_16x16x32_bf16 v[128:131], v[76:79], v[92:95], v[128:131]
    ds_read_b64_tr_b16 v[44:45], v19 offset:0
    v_mfma_f32_16x16x32_bf16 v[132:135], v[76:79], v[96:99], v[132:135]
    ds_read_b64_tr_b16 v[46:47], v19 offset:1024
    v_mfma_f32_16x16x32_bf16 v[136:139], v[76:79], v[100:103], v[136:139]
    ds_read_b64_tr_b16 v[48:49], v20 offset:0
    v_mfma_f32_16x16x32_bf16 v[140:143], v[80:83], v[92:95], v[140:143]
    ds_read_b64_tr_b16 v[50:51], v20 offset:1024
    v_mfma_f32_16x16x32_bf16 v[144:147], v[80:83], v[96:99], v[144:147]
    ds_read_b64_tr_b16 v[52:53], v21 offset:0
    v_mfma_f32_16x16x32_bf16 v[148:151], v[80:83], v[100:103], v[148:151]
    ds_read_b64_tr_b16 v[54:55], v21 offset:1024
    v_mfma_f32_16x16x32_bf16 v[152:155], v[84:87], v[92:95], v[152:155]
    v_mfma_f32_16x16x32_bf16 v[156:159], v[84:87], v[96:99], v[156:159]
    v_mfma_f32_16x16x32_bf16 v[160:163], v[84:87], v[100:103], v[160:163]
    v_mfma_f32_16x16x32_bf16 v[164:167], v[88:91], v[92:95], v[164:167]
    v_mfma_f32_16x16x32_bf16 v[168:171], v[88:91], v[96:99], v[168:171]
    v_mfma_f32_16x16x32_bf16 v[172:175], v[88:91], v[100:103], v[172:175]
    s_waitcnt lgkmcnt(0)
    v_mfma_f32_16x16x32_bf16 v[104:107], v[32:35], v[56:59], v[104:107]
    ds_read_b128 v[92:95], v23 offset:0
    ds_read_b64_tr_b16 v[68:69], v16 offset:12288
    v_mfma_f32_16x16x32_bf16 v[108:111], v[32:35], v[60:63], v[108:111]
    ds_read_b64_tr_b16 v[70:71], v16 offset:13312
    ds_read_b128 v[96:99], v23 offset:2048
    v_mfma_f32_16x16x32_bf16 v[112:115], v[32:35], v[64:67], v[112:115]
    ds_read_b128 v[100:103], v23 offset:4096
    ds_read_b64_tr_b16 v[72:73], v17 offset:12288
    v_mfma_f32_16x16x32_bf16 v[116:119], v[36:39], v[56:59], v[116:119]
    ds_read_b64_tr_b16 v[74:75], v17 offset:13312
    ds_read_b64_tr_b16 v[76:77], v18 offset:12288
    v_mfma_f32_16x16x32_bf16 v[120:123], v[36:39], v[60:63], v[120:123]
    ds_read_b64_tr_b16 v[78:79], v18 offset:13312
    v_mfma_f32_16x16x32_bf16 v[124:127], v[36:39], v[64:67], v[124:127]
    ds_read_b64_tr_b16 v[80:81], v19 offset:12288
    v_mfma_f32_16x16x32_bf16 v[128:131], v[40:43], v[56:59], v[128:131]
    ds_read_b64_tr_b16 v[82:83], v19 offset:13312
    v_mfma_f32_16x16x32_bf16 v[132:135], v[40:43], v[60:63], v[132:135]
    ds_read_b64_tr_b16 v[84:85], v20 offset:12288
    v_mfma_f32_16x16x32_bf16 v[136:139], v[40:43], v[64:67], v[136:139]
    ds_read_b64_tr_b16 v[86:87], v20 offset:13312
    v_mfma_f32_16x16x32_bf16 v[140:143], v[44:47], v[56:59], v[140:143]
    ds_read_b64_tr_b16 v[88:89], v21 offset:12288
    v_mfma_f32_16x16x32_bf16 v[144:147], v[44:47], v[60:63], v[144:147]
    ds_read_b64_tr_b16 v[90:91], v21 offset:13312
    v_mfma_f32_16x16x32_bf16 v[148:151], v[44:47], v[64:67], v[148:151]
    ds_read_b32 v15, v14 offset:64
    v_mfma_f32_16x16x32_bf16 v[152:155], v[48:51], v[56:59], v[152:155]
    v_mfma_f32_16x16x32_bf16 v[156:159], v[48:51], v[60:63], v[156:159]
    v_mfma_f32_16x16x32_bf16 v[160:163], v[48:51], v[64:67], v[160:163]
    v_mfma_f32_16x16x32_bf16 v[164:167], v[52:55], v[56:59], v[164:167]
    v_mfma_f32_16x16x32_bf16 v[168:171], v[52:55], v[60:63], v[168:171]
    v_mfma_f32_16x16x32_bf16 v[172:175], v[52:55], v[64:67], v[172:175]
    s_waitcnt lgkmcnt(0)
    v_cmp_ne_u32 vcc, 0, v15
    v_mfma_f32_16x16x32_bf16 v[104:107], v[68:71], v[92:95], v[104:107]
    s_barrier
    s_cbranch_vccnz L_slow4
L_cont4:
    v_mfma_f32_16x16x32_bf16 v[108:111], v[68:71], v[96:99], v[108:111]
    ds_read_b128 v[56:59], v22 offset:40960
    ds_read_b64_tr_b16 v[32:33], v16 offset:40960
    v_mfma_f32_16x16x32_bf16 v[112:115], v[68:71], v[100:103], v[112:115]
    ds_read_b64_tr_b16 v[34:35], v16 offset:41984
    ds_read_b128 v[60:63], v22 offset:43008
    v_mfma_f32_16x16x32_bf16 v[116:119], v[72:75], v[92:95], v[116:119]
    ds_read_b128 v[64:67], v22 offset:45056
    ds_read_b64_tr_b16 v[36:37], v17 offset:40960
    v_mfma_f32_16x16x32_bf16 v[120:123], v[72:75], v[96:99], v[120:123]
    ds_read_b64_tr_b16 v[38:39], v17 offset:41984
    ds_read_b64_tr_b16 v[40:41], v18 offset:40960
    v_mfma_f32_16x16x32_bf16 v[124:127], v[72:75], v[100:103], v[124:127]
    ds_read_b64_tr_b16 v[42:43], v18 offset:41984
    v_mfma_f32_16x16x32_bf16 v[128:131], v[76:79], v[92:95], v[128:131]
    ds_read_b64_tr_b16 v[44:45], v19 offset:40960
    v_mfma_f32_16x16x32_bf16 v[132:135], v[76:79], v[96:99], v[132:135]
    ds_read_b64_tr_b16 v[46:47], v19 offset:41984
    v_mfma_f32_16x16x32_bf16 v[136:139], v[76:79], v[100:103], v[136:139]
    ds_read_b64_tr_b16 v[48:49], v20 offset:40960
    v_mfma_f32_16x16x32_bf16 v[140:143], v[80:83], v[92:95], v[140:143]
    ds_read_b64_tr_b16 v[50:51], v20 offset:41984
    v_mfma_f32_16x16x32_bf16 v[144:147], v[80:83], v[96:99], v[144:147]
    ds_read_b64_tr_b16 v[52:53], v21 offset:40960
    v_mfma_f32_16x16x32_bf16 v[148:151], v[80:83], v[100:103], v[148:151]
    ds_read_b64_tr_b16 v[54:55], v21 offset:41984
    v_mfma_f32_16x16x32_bf16 v[152:155], v[84:87], v[92:95], v[152:155]
    v_mfma_f32_16x16x32_bf16 v[156:159], v[84:87], v[96:99], v[156:159]
    v_mfma_f32_16x16x32_bf16 v[160:163], v[84:87], v[100:103], v[160:163]
    v_mfma_f32_16x16x32_bf16 v[164:167], v[88:91], v[92:95], v[164:167]
    v_mfma_f32_16x16x32_bf16 v[168:171], v[88:91], v[96:99], v[168:171]
    v_mfma_f32_16x16x32_bf16 v[172:175], v[88:91], v[100:103], v[172:175]
    s_waitcnt lgkmcnt(0)
    v_mfma_f32_16x16x32_bf16 v[104:107], v[32:35], v[56:59], v[104:107]
    ds_read_b128 v[92:95], v23 offset:40960
    ds_read_b64_tr_b16 v[68:69], v16 offset:53248
    v_mfma_f32_16x16x32_bf16 v[108:111], v[32:35], v[60:63], v[108:111]
    ds_read_b64_tr_b16 v[70:71], v16 offset:54272
    ds_read_b128 v[96:99], v23 offset:43008
    v_mfma_f32_16x16x32_bf16 v[112:115], v[32:35], v[64:67], v[112:115]
    ds_read_b128 v[100:103], v23 offset:45056
    ds_read_b64_tr_b16 v[72:73], v17 offset:53248
    v_mfma_f32_16x16x32_bf16 v[116:119], v[36:39], v[56:59], v[116:119]
    ds_read_b64_tr_b16 v[74:75], v17 offset:54272
    ds_read_b64_tr_b16 v[76:77], v18 offset:53248
    v_mfma_f32_16x16x32_bf16 v[120:123], v[36:39], v[60:63], v[120:123]
    ds_read_b64_tr_b16 v[78:79], v18 offset:54272
    v_mfma_f32_16x16x32_bf16 v[124:127], v[36:39], v[64:67], v[124:127]
    ds_read_b64_tr_b16 v[80:81], v19 offset:53248
    v_mfma_f32_16x16x32_bf16 v[128:131], v[40:43], v[56:59], v[128:131]
    ds_read_b64_tr_b16 v[82:83], v19 offset:54272
    v_mfma_f32_16x16x32_bf16 v[132:135], v[40:43], v[60:63], v[132:135]
    ds_read_b64_tr_b16 v[84:85], v20 offset:53248
    v_mfma_f32_16x16x32_bf16 v[136:139], v[40:43], v[64:67], v[136:139]
    ds_read_b64_tr_b16 v[86:87], v20 offset:54272
    v_mfma_f32_16x16x32_bf16 v[140:143], v[44:47], v[56:59], v[140:143]
    ds_read_b64_tr_b16 v[88:89], v21 offset:53248
    v_mfma_f32_16x16x32_bf16 v[144:147], v[44:47], v[60:63], v[144:147]
    ds_read_b64_tr_b16 v[90:91], v21 offset:54272
    v_mfma_f32_16x16x32_bf16 v[148:151], v[44:47], v[64:67], v[148:151]
    ds_read_b32 v15, v14 offset:80
    v_mfma_f32_16x16x32_bf16 v[152:155], v[48:51], v[56:59], v[152:155]
    v_mfma_f32_16x16x32_bf16 v[156:159], v[48:51], v[60:63], v[156:159]
    v_mfma_f32_16x16x32_bf16 v[160:163], v[48:51], v[64:67], v[160:163]
    v_mfma_f32_16x16x32_bf16 v[164:167], v[52:55], v[56:59], v[164:167]
    v_mfma_f32_16x16x32_bf16 v[168:171], v[52:55], v[60:63], v[168:171]
    v_mfma_f32_16x16x32_bf16 v[172:175], v[52:55], v[64:67], v[172:175]
    s_waitcnt lgkmcnt(0)
    v_cmp_ne_u32 vcc, 0, v15
    v_mfma_f32_16x16x32_bf16 v[104:107], v[68:71], v[92:95], v[104:107]
    s_barrier
    s_cbranch_vccnz L_slow5
L_cont5:
    v_mfma_f32_16x16x32_bf16 v[108:111], v[68:71], v[96:99], v[108:111]
    ds_read_b128 v[56:59], v30 offset:0
    ds_read_b64_tr_b16 v[32:33], v24 offset:0
    v_mfma_f32_16x16x32_bf16 v[112:115], v[68:71], v[100:103], v[112:115]
    ds_read_b64_tr_b16 v[34:35], v24 offset:1024
    ds_read_b128 v[60:63], v30 offset:2048
    v_mfma_f32_16x16x32_bf16 v[116:119], v[72:75], v[92:95], v[116:119]
    ds_read_b128 v[64:67], v30 offset:4096
    ds_read_b64_tr_b16 v[36:37], v25 offset:0
    v_mfma_f32_16x16x32_bf16 v[120:123], v[72:75], v[96:99], v[120:123]
    ds_read_b64_tr_b16 v[38:39], v25 offset:1024
    ds_read_b64_tr_b16 v[40:41], v26 offset:0
    v_mfma_f32_16x16x32_bf16 v[124:127], v[72:75], v[100:103], v[124:127]
    ds_read_b64_tr_b16 v[42:43], v26 offset:1024
    v_mfma_f32_16x16x32_bf16 v[128:131], v[76:79], v[92:95], v[128:131]
    ds_read_b64_tr_b16 v[44:45], v27 offset:0
    v_mfma_f32_16x16x32_bf16 v[132:135], v[76:79], v[96:99], v[132:135]
    ds_read_b64_tr_b16 v[46:47], v27 offset:1024
    v_mfma_f32_16x16x32_bf16 v[136:139], v[76:79], v[100:103], v[136:139]
    ds_read_b64_tr_b16 v[48:49], v28 offset:0
    v_mfma_f32_16x16x32_bf16 v[140:143], v[80:83], v[92:95], v[140:143]
    ds_read_b64_tr_b16 v[50:51], v28 offset:1024
    v_mfma_f32_16x16x32_bf16 v[144:147], v[80:83], v[96:99], v[144:147]
    ds_read_b64_tr_b16 v[52:53], v29 offset:0
    v_mfma_f32_16x16x32_bf16 v[148:151], v[80:83], v[100:103], v[148:151]
    ds_read_b64_tr_b16 v[54:55], v29 offset:1024
    v_mfma_f32_16x16x32_bf16 v[152:155], v[84:87], v[92:95], v[152:155]
    v_mfma_f32_16x16x32_bf16 v[156:159], v[84:87], v[96:99], v[156:159]
    v_mfma_f32_16x16x32_bf16 v[160:163], v[84:87], v[100:103], v[160:163]
    v_mfma_f32_16x16x32_bf16 v[164:167], v[88:91], v[92:95], v[164:167]
    v_mfma_f32_16x16x32_bf16 v[168:171], v[88:91], v[96:99], v[168:171]
    v_mfma_f32_16x16x32_bf16 v[172:175], v[88:91], v[100:103], v[172:175]
    s_waitcnt lgkmcnt(0)
    v_mfma_f32_16x16x32_bf16 v[104:107], v[32:35], v[56:59], v[104:107]
    ds_read_b128 v[92:95], v31 offset:0
    ds_read_b64_tr_b16 v[68:69], v24 offset:12288
    v_mfma_f32_16x16x32_bf16 v[108:111], v[32:35], v[60:63], v[108:111]
    ds_read_b64_tr_b16 v[70:71], v24 offset:13312
    ds_read_b128 v[96:99], v31 offset:2048
    v_mfma_f32_16x16x32_bf16 v[112:115], v[32:35], v[64:67], v[112:115]
    ds_read_b128 v[100:103], v31 offset:4096
    ds_read_b64_tr_b16 v[72:73], v25 offset:12288
    v_mfma_f32_16x16x32_bf16 v[116:119], v[36:39], v[56:59], v[116:119]
    ds_read_b64_tr_b16 v[74:75], v25 offset:13312
    ds_read_b64_tr_b16 v[76:77], v26 offset:12288
    v_mfma_f32_16x16x32_bf16 v[120:123], v[36:39], v[60:63], v[120:123]
    ds_read_b64_tr_b16 v[78:79], v26 offset:13312
    v_mfma_f32_16x16x32_bf16 v[124:127], v[36:39], v[64:67], v[124:127]
    ds_read_b64_tr_b16 v[80:81], v27 offset:12288
    v_mfma_f32_16x16x32_bf16 v[128:131], v[40:43], v[56:59], v[128:131]
    ds_read_b64_tr_b16 v[82:83], v27 offset:13312
    v_mfma_f32_16x16x32_bf16 v[132:135], v[40:43], v[60:63], v[132:135]
    ds_read_b64_tr_b16 v[84:85], v28 offset:12288
    v_mfma_f32_16x16x32_bf16 v[136:139], v[40:43], v[64:67], v[136:139]
    ds_read_b64_tr_b16 v[86:87], v28 offset:13312
    v_mfma_f32_16x16x32_bf16 v[140:143], v[44:47], v[56:59], v[140:143]
    ds_read_b64_tr_b16 v[88:89], v29 offset:12288
    v_mfma_f32_16x16x32_bf16 v[144:147], v[44:47], v[60:63], v[144:147]
    ds_read_b64_tr_b16 v[90:91], v29 offset:13312
    v_mfma_f32_16x16x32_bf16 v[148:151], v[44:47], v[64:67], v[148:151]
    ds_read_b32 v15, v14 offset:96
    v_mfma_f32_16x16x32_bf16 v[152:155], v[48:51], v[56:59], v[152:155]
    v_mfma_f32_16x16x32_bf16 v[156:159], v[48:51], v[60:63], v[156:159]
    v_mfma_f32_16x16x32_bf16 v[160:163], v[48:51], v[64:67], v[160:163]
    v_mfma_f32_16x16x32_bf16 v[164:167], v[52:55], v[56:59], v[164:167]
    v_mfma_f32_16x16x32_bf16 v[168:171], v[52:55], v[60:63], v[168:171]
    v_mfma_f32_16x16x32_bf16 v[172:175], v[52:55], v[64:67], v[172:175]
    s_waitcnt lgkmcnt(0)
    v_cmp_ne_u32 vcc, 0, v15
    v_mfma_f32_16x16x32_bf16 v[104:107], v[68:71], v[92:95], v[104:107]
    s_barrier
    s_cbranch_vccnz L_slow6
L_cont6:
    v_mfma_f32_16x16x32_bf16 v[108:111], v[68:71], v[96:99], v[108:111]
    ds_read_b128 v[56:59], v22 offset:0
    ds_read_b64_tr_b16 v[32:33], v16 offset:0
    v_mfma_f32_16x16x32_bf16 v[112:115], v[68:71], v[100:103], v[112:115]
    ds_read_b64_tr_b16 v[34:35], v16 offset:1024
    ds_read_b128 v[60:63], v22 offset:2048
    v_mfma_f32_16x16x32_bf16 v[116:119], v[72:75], v[92:95], v[116:119]
    ds_read_b128 v[64:67], v22 offset:4096
    ds_read_b64_tr_b16 v[36:37], v17 offset:0
    v_mfma_f32_16x16x32_bf16 v[120:123], v[72:75], v[96:99], v[120:123]
    ds_read_b64_tr_b16 v[38:39], v17 offset:1024
    ds_read_b64_tr_b16 v[40:41], v18 offset:0
    v_mfma_f32_16x16x32_bf16 v[124:127], v[72:75], v[100:103], v[124:127]
    ds_read_b64_tr_b16 v[42:43], v18 offset:1024
    v_mfma_f32_16x16x32_bf16 v[128:131], v[76:79], v[92:95], v[128:131]
    ds_read_b64_tr_b16 v[44:45], v19 offset:0
    v_mfma_f32_16x16x32_bf16 v[132:135], v[76:79], v[96:99], v[132:135]
    ds_read_b64_tr_b16 v[46:47], v19 offset:1024
    v_mfma_f32_16x16x32_bf16 v[136:139], v[76:79], v[100:103], v[136:139]
    ds_read_b64_tr_b16 v[48:49], v20 offset:0
    v_mfma_f32_16x16x32_bf16 v[140:143], v[80:83], v[92:95], v[140:143]
    ds_read_b64_tr_b16 v[50:51], v20 offset:1024
    v_mfma_f32_16x16x32_bf16 v[144:147], v[80:83], v[96:99], v[144:147]
    ds_read_b64_tr_b16 v[52:53], v21 offset:0
    v_mfma_f32_16x16x32_bf16 v[148:151], v[80:83], v[100:103], v[148:151]
    ds_read_b64_tr_b16 v[54:55], v21 offset:1024
    v_mfma_f32_16x16x32_bf16 v[152:155], v[84:87], v[92:95], v[152:155]
    v_mfma_f32_16x16x32_bf16 v[156:159], v[84:87], v[96:99], v[156:159]
    v_mfma_f32_16x16x32_bf16 v[160:163], v[84:87], v[100:103], v[160:163]
    v_mfma_f32_16x16x32_bf16 v[164:167], v[88:91], v[92:95], v[164:167]
    v_mfma_f32_16x16x32_bf16 v[168:171], v[88:91], v[96:99], v[168:171]
    v_mfma_f32_16x16x32_bf16 v[172:175], v[88:91], v[100:103], v[172:175]
    s_waitcnt lgkmcnt(0)
    v_mfma_f32_16x16x32_bf16 v[104:107], v[32:35], v[56:59], v[104:107]
    ds_read_b128 v[92:95], v23 offset:0
    ds_read_b64_tr_b16 v[68:69], v16 offset:12288
    v_mfma_f32_16x16x32_bf16 v[108:111], v[32:35], v[60:63], v[108:111]
    ds_read_b64_tr_b16 v[70:71], v16 offset:13312
    ds_read_b128 v[96:99], v23 offset:2048
    v_mfma_f32_16x16x32_bf16 v[112:115], v[32:35], v[64:67], v[112:115]
    ds_read_b128 v[100:103], v23 offset:4096
    ds_read_b64_tr_b16 v[72:73], v17 offset:12288
    v_mfma_f32_16x16x32_bf16 v[116:119], v[36:39], v[56:59], v[116:119]
    ds_read_b64_tr_b16 v[74:75], v17 offset:13312
    ds_read_b64_tr_b16 v[76:77], v18 offset:12288
    v_mfma_f32_16x16x32_bf16 v[120:123], v[36:39], v[60:63], v[120:123]
    ds_read_b64_tr_b16 v[78:79], v18 offset:13312
    v_mfma_f32_16x16x32_bf16 v[124:127], v[36:39], v[64:67], v[124:127]
    ds_read_b64_tr_b16 v[80:81], v19 offset:12288
    v_mfma_f32_16x16x32_bf16 v[128:131], v[40:43], v[56:59], v[128:131]
    ds_read_b64_tr_b16 v[82:83], v19 offset:13312
    v_mfma_f32_16x16x32_bf16 v[132:135], v[40:43], v[60:63], v[132:135]
    ds_read_b64_tr_b16 v[84:85], v20 offset:12288
    v_mfma_f32_16x16x32_bf16 v[136:139], v[40:43], v[64:67], v[136:139]
    ds_read_b64_tr_b16 v[86:87], v20 offset:13312
    v_mfma_f32_16x16x32_bf16 v[140:143], v[44:47], v[56:59], v[140:143]
    ds_read_b64_tr_b16 v[88:89], v21 offset:12288
    v_mfma_f32_16x16x32_bf16 v[144:147], v[44:47], v[60:63], v[144:147]
    ds_read_b64_tr_b16 v[90:91], v21 offset:13312
    v_mfma_f32_16x16x32_bf16 v[148:151], v[44:47], v[64:67], v[148:151]
    ds_read_b32 v15, v14 offset:112
    v_mfma_f32_16x16x32_bf16 v[152:155], v[48:51], v[56:59], v[152:155]
    v_mfma_f32_16x16x32_bf16 v[156:159], v[48:51], v[60:63], v[156:159]
    v_mfma_f32_16x16x32_bf16 v[160:163], v[48:51], v[64:67], v[160:163]
    v_mfma_f32_16x16x32_bf16 v[164:167], v[52:55], v[56:59], v[164:167]
    v_mfma_f32_16x16x32_bf16 v[168:171], v[52:55], v[60:63], v[168:171]
    v_mfma_f32_16x16x32_bf16 v[172:175], v[52:55], v[64:67], v[172:175]
    s_waitcnt lgkmcnt(0)
    v_cmp_ne_u32 vcc, 0, v15
    v_mfma_f32_16x16x32_bf16 v[104:107], v[68:71], v[92:95], v[104:107]
    s_barrier
    s_cbranch_vccnz L_slow7
L_cont7:
    v_mfma_f32_16x16x32_bf16 v[108:111], v[68:71], v[96:99], v[108:111]
    ds_read_b128 v[56:59], v22 offset:40960
    ds_read_b64_tr_b16 v[32:33], v16 offset:40960
    v_mfma_f32_16x16x32_bf16 v[112:115], v[68:71], v[100:103], v[112:115]
    ds_read_b64_tr_b16 v[34:35], v16 offset:41984
    ds_read_b128 v[60:63], v22 offset:43008
    v_mfma_f32_16x16x32_bf16 v[116:119], v[72:75], v[92:95], v[116:119]
    ds_read_b128 v[64:67], v22 offset:45056
    ds_read_b64_tr_b16 v[36:37], v17 offset:40960
    v_mfma_f32_16x16x32_bf16 v[120:123], v[72:75], v[96:99], v[120:123]
    ds_read_b64_tr_b16 v[38:39], v17 offset:41984
    ds_read_b64_tr_b16 v[40:41], v18 offset:40960
    v_mfma_f32_16x16x32_bf16 v[124:127], v[72:75], v[100:103], v[124:127]
    ds_read_b64_tr_b16 v[42:43], v18 offset:41984
    v_mfma_f32_16x16x32_bf16 v[128:131], v[76:79], v[92:95], v[128:131]
    ds_read_b64_tr_b16 v[44:45], v19 offset:40960
    v_mfma_f32_16x16x32_bf16 v[132:135], v[76:79], v[96:99], v[132:135]
    ds_read_b64_tr_b16 v[46:47], v19 offset:41984
    v_mfma_f32_16x16x32_bf16 v[136:139], v[76:79], v[100:103], v[136:139]
    ds_read_b64_tr_b16 v[48:49], v20 offset:40960
    v_mfma_f32_16x16x32_bf16 v[140:143], v[80:83], v[92:95], v[140:143]
    ds_read_b64_tr_b16 v[50:51], v20 offset:41984
    v_mfma_f32_16x16x32_bf16 v[144:147], v[80:83], v[96:99], v[144:147]
    ds_read_b64_tr_b16 v[52:53], v21 offset:40960
    v_mfma_f32_16x16x32_bf16 v[148:151], v[80:83], v[100:103], v[148:151]
    ds_read_b64_tr_b16 v[54:55], v21 offset:41984
    v_mfma_f32_16x16x32_bf16 v[152:155], v[84:87], v[92:95], v[152:155]
    v_mfma_f32_16x16x32_bf16 v[156:159], v[84:87], v[96:99], v[156:159]
    v_mfma_f32_16x16x32_bf16 v[160:163], v[84:87], v[100:103], v[160:163]
    v_mfma_f32_16x16x32_bf16 v[164:167], v[88:91], v[92:95], v[164:167]
    v_mfma_f32_16x16x32_bf16 v[168:171], v[88:91], v[96:99], v[168:171]
    v_mfma_f32_16x16x32_bf16 v[172:175], v[88:91], v[100:103], v[172:175]
    s_waitcnt lgkmcnt(0)
    v_mfma_f32_16x16x32_bf16 v[104:107], v[32:35], v[56:59], v[104:107]
    ds_read_b128 v[92:95], v23 offset:40960
    ds_read_b64_tr_b16 v[68:69], v16 offset:53248
    v_mfma_f32_16x16x32_bf16 v[108:111], v[32:35], v[60:63], v[108:111]
    ds_read_b64_tr_b16 v[70:71], v16 offset:54272
    ds_read_b128 v[96:99], v23 offset:43008
    v_mfma_f32_16x16x32_bf16 v[112:115], v[32:35], v[64:67], v[112:115]
    ds_read_b128 v[100:103], v23 offset:45056
    ds_read_b64_tr_b16 v[72:73], v17 offset:53248
    v_mfma_f32_16x16x32_bf16 v[116:119], v[36:39], v[56:59], v[116:119]
    ds_read_b64_tr_b16 v[74:75], v17 offset:54272
    ds_read_b64_tr_b16 v[76:77], v18 offset:53248
    v_mfma_f32_16x16x32_bf16 v[120:123], v[36:39], v[60:63], v[120:123]
    ds_read_b64_tr_b16 v[78:79], v18 offset:54272
    v_mfma_f32_16x16x32_bf16 v[124:127], v[36:39], v[64:67], v[124:127]
    ds_read_b64_tr_b16 v[80:81], v19 offset:53248
    v_mfma_f32_16x16x32_bf16 v[128:131], v[40:43], v[56:59], v[128:131]
    ds_read_b64_tr_b16 v[82:83], v19 offset:54272
    v_mfma_f32_16x16x32_bf16 v[132:135], v[40:43], v[60:63], v[132:135]
    ds_read_b64_tr_b16 v[84:85], v20 offset:53248
    v_mfma_f32_16x16x32_bf16 v[136:139], v[40:43], v[64:67], v[136:139]
    ds_read_b64_tr_b16 v[86:87], v20 offset:54272
    v_mfma_f32_16x16x32_bf16 v[140:143], v[44:47], v[56:59], v[140:143]
    ds_read_b64_tr_b16 v[88:89], v21 offset:53248
    v_mfma_f32_16x16x32_bf16 v[144:147], v[44:47], v[60:63], v[144:147]
    ds_read_b64_tr_b16 v[90:91], v21 offset:54272
    v_mfma_f32_16x16x32_bf16 v[148:151], v[44:47], v[64:67], v[148:151]
    ds_read_b32 v15, v14 offset:128
    v_mfma_f32_16x16x32_bf16 v[152:155], v[48:51], v[56:59], v[152:155]
    v_mfma_f32_16x16x32_bf16 v[156:159], v[48:51], v[60:63], v[156:159]
    v_mfma_f32_16x16x32_bf16 v[160:163], v[48:51], v[64:67], v[160:163]
    v_mfma_f32_16x16x32_bf16 v[164:167], v[52:55], v[56:59], v[164:167]
    v_mfma_f32_16x16x32_bf16 v[168:171], v[52:55], v[60:63], v[168:171]
    v_mfma_f32_16x16x32_bf16 v[172:175], v[52:55], v[64:67], v[172:175]
    s_waitcnt lgkmcnt(0)
    v_cmp_ne_u32 vcc, 0, v15
    v_mfma_f32_16x16x32_bf16 v[104:107], v[68:71], v[92:95], v[104:107]
    s_barrier
    s_cbranch_vccnz L_slow8
L_cont8:
    v_mfma_f32_16x16x32_bf16 v[108:111], v[68:71], v[96:99], v[108:111]
    ds_read_b128 v[56:59], v30 offset:0
    ds_read_b64_tr_b16 v[32:33], v24 offset:0
    v_mfma_f32_16x16x32_bf16 v[112:115], v[68:71], v[100:103], v[112:115]
    ds_read_b64_tr_b16 v[34:35], v24 offset:1024
    ds_read_b128 v[60:63], v30 offset:2048
    v_mfma_f32_16x16x32_bf16 v[116:119], v[72:75], v[92:95], v[116:119]
    ds_read_b128 v[64:67], v30 offset:4096
    ds_read_b64_tr_b16 v[36:37], v25 offset:0
    v_mfma_f32_16x16x32_bf16 v[120:123], v[72:75], v[96:99], v[120:123]
    ds_read_b64_tr_b16 v[38:39], v25 offset:1024
    ds_read_b64_tr_b16 v[40:41], v26 offset:0
    v_mfma_f32_16x16x32_bf16 v[124:127], v[72:75], v[100:103], v[124:127]
    ds_read_b64_tr_b16 v[42:43], v26 offset:1024
    v_mfma_f32_16x16x32_bf16 v[128:131], v[76:79], v[92:95], v[128:131]
    ds_read_b64_tr_b16 v[44:45], v27 offset:0
    v_mfma_f32_16x16x32_bf16 v[132:135], v[76:79], v[96:99], v[132:135]
    ds_read_b64_tr_b16 v[46:47], v27 offset:1024
    v_mfma_f32_16x16x32_bf16 v[136:139], v[76:79], v[100:103], v[136:139]
    ds_read_b64_tr_b16 v[48:49], v28 offset:0
    v_mfma_f32_16x16x32_bf16 v[140:143], v[80:83], v[92:95], v[140:143]
    ds_read_b64_tr_b16 v[50:51], v28 offset:1024
    v_mfma_f32_16x16x32_bf16 v[144:147], v[80:83], v[96:99], v[144:147]
    ds_read_b64_tr_b16 v[52:53], v29 offset:0
    v_mfma_f32_16x16x32_bf16 v[148:151], v[80:83], v[100:103], v[148:151]
    ds_read_b64_tr_b16 v[54:55], v29 offset:1024
    v_mfma_f32_16x16x32_bf16 v[152:155], v[84:87], v[92:95], v[152:155]
    v_mfma_f32_16x16x32_bf16 v[156:159], v[84:87], v[96:99], v[156:159]
    v_mfma_f32_16x16x32_bf16 v[160:163], v[84:87], v[100:103], v[160:163]
    v_mfma_f32_16x16x32_bf16 v[164:167], v[88:91], v[92:95], v[164:167]
    v_mfma_f32_16x16x32_bf16 v[168:171], v[88:91], v[96:99], v[168:171]
    v_mfma_f32_16x16x32_bf16 v[172:175], v[88:91], v[100:103], v[172:175]
    s_waitcnt lgkmcnt(0)
    v_mfma_f32_16x16x32_bf16 v[104:107], v[32:35], v[56:59], v[104:107]
    ds_read_b128 v[92:95], v31 offset:0
    ds_read_b64_tr_b16 v[68:69], v24 offset:12288
    v_mfma_f32_16x16x32_bf16 v[108:111], v[32:35], v[60:63], v[108:111]
    ds_read_b64_tr_b16 v[70:71], v24 offset:13312
    ds_read_b128 v[96:99], v31 offset:2048
    v_mfma_f32_16x16x32_bf16 v[112:115], v[32:35], v[64:67], v[112:115]
    ds_read_b128 v[100:103], v31 offset:4096
    ds_read_b64_tr_b16 v[72:73], v25 offset:12288
    v_mfma_f32_16x16x32_bf16 v[116:119], v[36:39], v[56:59], v[116:119]
    ds_read_b64_tr_b16 v[74:75], v25 offset:13312
    ds_read_b64_tr_b16 v[76:77], v26 offset:12288
    v_mfma_f32_16x16x32_bf16 v[120:123], v[36:39], v[60:63], v[120:123]
    ds_read_b64_tr_b16 v[78:79], v26 offset:13312
    v_mfma_f32_16x16x32_bf16 v[124:127], v[36:39], v[64:67], v[124:127]
    ds_read_b64_tr_b16 v[80:81], v27 offset:12288
    v_mfma_f32_16x16x32_bf16 v[128:131], v[40:43], v[56:59], v[128:131]
    ds_read_b64_tr_b16 v[82:83], v27 offset:13312
    v_mfma_f32_16x16x32_bf16 v[132:135], v[40:43], v[60:63], v[132:135]
    ds_read_b64_tr_b16 v[84:85], v28 offset:12288
    v_mfma_f32_16x16x32_bf16 v[136:139], v[40:43], v[64:67], v[136:139]
    ds_read_b64_tr_b16 v[86:87], v28 offset:13312
    v_mfma_f32_16x16x32_bf16 v[140:143], v[44:47], v[56:59], v[140:143]
    ds_read_b64_tr_b16 v[88:89], v29 offset:12288
    v_mfma_f32_16x16x32_bf16 v[144:147], v[44:47], v[60:63], v[144:147]
    ds_read_b64_tr_b16 v[90:91], v29 offset:13312
    v_mfma_f32_16x16x32_bf16 v[148:151], v[44:47], v[64:67], v[148:151]
    ds_read_b32 v15, v14 offset:144
    v_mfma_f32_16x16x32_bf16 v[152:155], v[48:51], v[56:59], v[152:155]
    v_mfma_f32_16x16x32_bf16 v[156:159], v[48:51], v[60:63], v[156:159]
    v_mfma_f32_16x16x32_bf16 v[160:163], v[48:51], v[64:67], v[160:163]
    v_mfma_f32_16x16x32_bf16 v[164:167], v[52:55], v[56:59], v[164:167]
    v_mfma_f32_16x16x32_bf16 v[168:171], v[52:55], v[60:63], v[168:171]
    v_mfma_f32_16x16x32_bf16 v[172:175], v[52:55], v[64:67], v[172:175]
    s_waitcnt lgkmcnt(0)
    v_cmp_ne_u32 vcc, 0, v15
    v_mfma_f32_16x16x32_bf16 v[104:107], v[68:71], v[92:95], v[104:107]
    s_barrier
    s_cbranch_vccnz L_slow9
L_cont9:
    v_mfma_f32_16x16x32_bf16 v[108:111], v[68:71], v[96:99], v[108:111]
    ds_read_b128 v[56:59], v22 offset:0
    ds_read_b64_tr_b16 v[32:33], v16 offset:0
    v_mfma_f32_16x16x32_bf16 v[112:115], v[68:71], v[100:103], v[112:115]
    ds_read_b64_tr_b16 v[34:35], v16 offset:1024
    ds_read_b128 v[60:63], v22 offset:2048
    v_mfma_f32_16x16x32_bf16 v[116:119], v[72:75], v[92:95], v[116:119]
    ds_read_b128 v[64:67], v22 offset:4096
    ds_read_b64_tr_b16 v[36:37], v17 offset:0
    v_mfma_f32_16x16x32_bf16 v[120:123], v[72:75], v[96:99], v[120:123]
    ds_read_b64_tr_b16 v[38:39], v17 offset:1024
    ds_read_b64_tr_b16 v[40:41], v18 offset:0
    v_mfma_f32_16x16x32_bf16 v[124:127], v[72:75], v[100:103], v[124:127]
    ds_read_b64_tr_b16 v[42:43], v18 offset:1024
    v_mfma_f32_16x16x32_bf16 v[128:131], v[76:79], v[92:95], v[128:131]
    ds_read_b64_tr_b16 v[44:45], v19 offset:0
    v_mfma_f32_16x16x32_bf16 v[132:135], v[76:79], v[96:99], v[132:135]
    ds_read_b64_tr_b16 v[46:47], v19 offset:1024
    v_mfma_f32_16x16x32_bf16 v[136:139], v[76:79], v[100:103], v[136:139]
    ds_read_b64_tr_b16 v[48:49], v20 offset:0
    v_mfma_f32_16x16x32_bf16 v[140:143], v[80:83], v[92:95], v[140:143]
    ds_read_b64_tr_b16 v[50:51], v20 offset:1024
    v_mfma_f32_16x16x32_bf16 v[144:147], v[80:83], v[96:99], v[144:147]
    ds_read_b64_tr_b16 v[52:53], v21 offset:0
    v_mfma_f32_16x16x32_bf16 v[148:151], v[80:83], v[100:103], v[148:151]
    ds_read_b64_tr_b16 v[54:55], v21 offset:1024
    v_mfma_f32_16x16x32_bf16 v[152:155], v[84:87], v[92:95], v[152:155]
    v_mfma_f32_16x16x32_bf16 v[156:159], v[84:87], v[96:99], v[156:159]
    v_mfma_f32_16x16x32_bf16 v[160:163], v[84:87], v[100:103], v[160:163]
    v_mfma_f32_16x16x32_bf16 v[164:167], v[88:91], v[92:95], v[164:167]
    v_mfma_f32_16x16x32_bf16 v[168:171], v[88:91], v[96:99], v[168:171]
    v_mfma_f32_16x16x32_bf16 v[172:175], v[88:91], v[100:103], v[172:175]
    s_waitcnt lgkmcnt(0)
    v_mfma_f32_16x16x32_bf16 v[104:107], v[32:35], v[56:59], v[104:107]
    ds_read_b128 v[92:95], v23 offset:0
    ds_read_b64_tr_b16 v[68:69], v16 offset:12288
    v_mfma_f32_16x16x32_bf16 v[108:111], v[32:35], v[60:63], v[108:111]
    ds_read_b64_tr_b16 v[70:71], v16 offset:13312
    ds_read_b128 v[96:99], v23 offset:2048
    v_mfma_f32_16x16x32_bf16 v[112:115], v[32:35], v[64:67], v[112:115]
    ds_read_b128 v[100:103], v23 offset:4096
    ds_read_b64_tr_b16 v[72:73], v17 offset:12288
    v_mfma_f32_16x16x32_bf16 v[116:119], v[36:39], v[56:59], v[116:119]
    ds_read_b64_tr_b16 v[74:75], v17 offset:13312
    ds_read_b64_tr_b16 v[76:77], v18 offset:12288
    v_mfma_f32_16x16x32_bf16 v[120:123], v[36:39], v[60:63], v[120:123]
    ds_read_b64_tr_b16 v[78:79], v18 offset:13312
    v_mfma_f32_16x16x32_bf16 v[124:127], v[36:39], v[64:67], v[124:127]
    ds_read_b64_tr_b16 v[80:81], v19 offset:12288
    v_mfma_f32_16x16x32_bf16 v[128:131], v[40:43], v[56:59], v[128:131]
    ds_read_b64_tr_b16 v[82:83], v19 offset:13312
    v_mfma_f32_16x16x32_bf16 v[132:135], v[40:43], v[60:63], v[132:135]
    ds_read_b64_tr_b16 v[84:85], v20 offset:12288
    v_mfma_f32_16x16x32_bf16 v[136:139], v[40:43], v[64:67], v[136:139]
    ds_read_b64_tr_b16 v[86:87], v20 offset:13312
    v_mfma_f32_16x16x32_bf16 v[140:143], v[44:47], v[56:59], v[140:143]
    ds_read_b64_tr_b16 v[88:89], v21 offset:12288
    v_mfma_f32_16x16x32_bf16 v[144:147], v[44:47], v[60:63], v[144:147]
    ds_read_b64_tr_b16 v[90:91], v21 offset:13312
    v_mfma_f32_16x16x32_bf16 v[148:151], v[44:47], v[64:67], v[148:151]
    ds_read_b32 v15, v14 offset:160
    v_mfma_f32_16x16x32_bf16 v[152:155], v[48:51], v[56:59], v[152:155]
    v_mfma_f32_16x16x32_bf16 v[156:159], v[48:51], v[60:63], v[156:159]
    v_mfma_f32_16x16x32_bf16 v[160:163], v[48:51], v[64:67], v[160:163]
    v_mfma_f32_16x16x32_bf16 v[164:167], v[52:55], v[56:59], v[164:167]
    v_mfma_f32_16x16x32_bf16 v[168:171], v[52:55], v[60:63], v[168:171]
    v_mfma_f32_16x16x32_bf16 v[172:175], v[52:55], v[64:67], v[172:175]
    s_waitcnt lgkmcnt(0)
    v_cmp_ne_u32 vcc, 0, v15
    v_mfma_f32_16x16x32_bf16 v[104:107], v[68:71], v[92:95], v[104:107]
    s_barrier
    s_cbranch_vccnz L_slow10
L_cont10:
    v_mfma_f32_16x16x32_bf16 v[108:111], v[68:71], v[96:99], v[108:111]
    ds_read_b64 v[32:33], v182 offset:0
    ds_read_b64 v[34:35], v183 offset:0
    v_mfma_f32_16x16x32_bf16 v[112:115], v[68:71], v[100:103], v[112:115]
    ds_read_b64 v[44:45], v182 offset:2048
    ds_read_b64 v[46:47], v183 offset:2048
    v_mfma_f32_16x16x32_bf16 v[116:119], v[72:75], v[92:95], v[116:119]
    ds_read_b64 v[56:57], v182 offset:4096
    ds_read_b64 v[58:59], v183 offset:4096
    v_mfma_f32_16x16x32_bf16 v[120:123], v[72:75], v[96:99], v[120:123]
    ds_read_b64 v[36:37], v184 offset:0
    ds_read_b64 v[38:39], v185 offset:0
    v_mfma_f32_16x16x32_bf16 v[124:127], v[72:75], v[100:103], v[124:127]
    ds_read_b64 v[48:49], v184 offset:2048
    ds_read_b64 v[50:51], v185 offset:2048
    v_mfma_f32_16x16x32_bf16 v[128:131], v[76:79], v[92:95], v[128:131]
    ds_read_b64 v[60:61], v184 offset:4096
    ds_read_b64 v[62:63], v185 offset:4096
    v_mfma_f32_16x16x32_bf16 v[132:135], v[76:79], v[96:99], v[132:135]
    ds_read_b64 v[40:41], v186 offset:0
    ds_read_b64 v[42:43], v187 offset:0
    v_mfma_f32_16x16x32_bf16 v[136:139], v[76:79], v[100:103], v[136:139]
    ds_read_b64 v[52:53], v186 offset:2048
    ds_read_b64 v[54:55], v187 offset:2048
    v_mfma_f32_16x16x32_bf16 v[140:143], v[80:83], v[92:95], v[140:143]
    ds_read_b64 v[64:65], v186 offset:4096
    ds_read_b64 v[66:67], v187 offset:4096
    v_mfma_f32_16x16x32_bf16 v[144:147], v[80:83], v[96:99], v[144:147]
    v_cvt_pk_bf16_f32 v192, v104, v105
    v_cvt_pk_bf16_f32 v193, v106, v107
    v_mfma_f32_16x16x32_bf16 v[148:151], v[80:83], v[100:103], v[148:151]
    v_cvt_pk_bf16_f32 v196, v108, v109
    v_cvt_pk_bf16_f32 v197, v110, v111
    v_mfma_f32_16x16x32_bf16 v[152:155], v[84:87], v[92:95], v[152:155]
    v_cvt_pk_bf16_f32 v200, v112, v113
    v_cvt_pk_bf16_f32 v201, v114, v115
    v_mfma_f32_16x16x32_bf16 v[156:159], v[84:87], v[96:99], v[156:159]
    v_cvt_pk_bf16_f32 v194, v116, v117
    v_cvt_pk_bf16_f32 v195, v118, v119
    v_mfma_f32_16x16x32_bf16 v[160:163], v[84:87], v[100:103], v[160:163]
    v_cvt_pk_bf16_f32 v198, v120, v121
    v_cvt_pk_bf16_f32 v199, v122, v123
    v_mfma_f32_16x16x32_bf16 v[164:167], v[88:91], v[92:95], v[164:167]
    v_cvt_pk_bf16_f32 v202, v124, v125
    v_cvt_pk_bf16_f32 v203, v126, v127
    v_mfma_f32_16x16x32_bf16 v[168:171], v[88:91], v[96:99], v[168:171]
    v_cvt_pk_bf16_f32 v204, v128, v129
    v_cvt_pk_bf16_f32 v205, v130, v131
    v_mfma_f32_16x16x32_bf16 v[172:175], v[88:91], v[100:103], v[172:175]
    v_cvt_pk_bf16_f32 v208, v132, v133
    v_cvt_pk_bf16_f32 v209, v134, v135
    s_waitcnt lgkmcnt(0)
    v_mfma_f32_16x16x32_bf16 v[236:239], v[56:59], v[192:195], 0
    v_cvt_pk_bf16_f32 v212, v136, v137
    v_cvt_pk_bf16_f32 v213, v138, v139
    v_mfma_f32_16x16x32_bf16 v[26:29], v[56:59], v[196:199], 0
    v_cvt_pk_bf16_f32 v206, v140, v141
    v_cvt_pk_bf16_f32 v207, v142, v143
    v_mfma_f32_16x16x32_bf16 v[182:185], v[56:59], v[200:203], 0
    v_cvt_pk_bf16_f32 v210, v144, v145
    v_cvt_pk_bf16_f32 v211, v146, v147
    v_mfma_f32_16x16x32_bf16 v[110:113], v[32:35], v[192:195], 0
    v_cvt_pk_bf16_f32 v214, v148, v149
    v_cvt_pk_bf16_f32 v215, v150, v151
    v_mfma_f32_16x16x32_bf16 v[122:125], v[32:35], v[196:199], 0
    v_cvt_pk_bf16_f32 v216, v152, v153
    v_cvt_pk_bf16_f32 v217, v154, v155
    v_mfma_f32_16x16x32_bf16 v[134:137], v[32:35], v[200:203], 0
    v_cvt_pk_bf16_f32 v220, v156, v157
    v_cvt_pk_bf16_f32 v221, v158, v159
    v_mfma_f32_16x16x32_bf16 v[146:149], v[44:47], v[192:195], 0
    v_cvt_pk_bf16_f32 v224, v160, v161
    v_cvt_pk_bf16_f32 v225, v162, v163
    v_cvt_pk_bf16_f32 v218, v164, v165
    v_cvt_pk_bf16_f32 v219, v166, v167
    v_cvt_pk_bf16_f32 v222, v168, v169
    v_cvt_pk_bf16_f32 v223, v170, v171
    v_cvt_pk_bf16_f32 v226, v172, v173
    v_cvt_pk_bf16_f32 v227, v174, v175
    v_mfma_f32_16x16x32_bf16 v[158:161], v[44:47], v[196:199], 0
    v_mfma_f32_16x16x32_bf16 v[164:167], v[44:47], v[200:203], 0
    v_mfma_f32_16x16x32_bf16 v[110:113], v[36:39], v[204:207], v[110:113]
    v_mov_b32 v16, v176
    v_mfma_f32_16x16x32_bf16 v[122:125], v[36:39], v[208:211], v[122:125]
    v_mov_b32 v17, v177
    v_mfma_f32_16x16x32_bf16 v[134:137], v[36:39], v[212:215], v[134:137]
    v_mov_b32 v18, v178
    v_mfma_f32_16x16x32_bf16 v[146:149], v[48:51], v[204:207], v[146:149]
    v_mov_b32 v19, v179
    v_mfma_f32_16x16x32_bf16 v[158:161], v[48:51], v[208:211], v[158:161]
    v_mov_b32 v20, v189
    v_mfma_f32_16x16x32_bf16 v[164:167], v[48:51], v[212:215], v[164:167]
    v_mov_b32 v21, v190
    v_mfma_f32_16x16x32_bf16 v[236:239], v[60:63], v[204:207], v[236:239]
    v_mfma_f32_16x16x32_bf16 v[26:29], v[60:63], v[208:211], v[26:29]
    v_mfma_f32_16x16x32_bf16 v[182:185], v[60:63], v[212:215], v[182:185]
    s_cmp_lg_u32 s61, 0
    s_cbranch_scc1 L_sl1
    v_mfma_f32_16x16x32_bf16 v[68:71], v[40:43], v[224:227], v[134:137]
    v_mfma_f32_16x16x32_bf16 v[72:75], v[52:55], v[224:227], v[164:167]
    v_mfma_f32_16x16x32_bf16 v[76:79], v[64:67], v[224:227], v[182:185]
    v_mfma_f32_16x16x32_bf16 v[122:125], v[40:43], v[220:223], v[122:125]
    v_mfma_f32_16x16x32_bf16 v[158:161], v[52:55], v[220:223], v[158:161]
    v_mfma_f32_16x16x32_bf16 v[26:29], v[64:67], v[220:223], v[26:29]
    v_mfma_f32_16x16x32_bf16 v[110:113], v[40:43], v[216:219], v[110:113]
    v_mfma_f32_16x16x32_bf16 v[146:149], v[52:55], v[216:219], v[146:149]
    v_mfma_f32_16x16x32_bf16 v[236:239], v[64:67], v[216:219], v[236:239]
    ds_write_b128 v180, v[68:71] offset:0
    ds_write_b128 v180, v[72:75] offset:1024
    ds_write_b128 v180, v[76:79] offset:2048
    ds_write_b128 v180, v[122:125] offset:3072
    ds_write_b128 v180, v[158:161] offset:4096
    ds_write_b128 v180, v[26:29] offset:5120
L_sld:
    s_waitcnt lgkmcnt(0) vmcnt(0)
    s_barrier
    ds_read_b128 v[80:83], v181 offset:0
    ds_read_b128 v[84:87], v181 offset:1024
    ds_read_b128 v[88:91], v181 offset:2048
    ds_read_b128 v[92:95], v181 offset:3072
    ds_read_b128 v[96:99], v181 offset:4096
    ds_read_b128 v[100:103], v181 offset:5120
    s_waitcnt lgkmcnt(3)
    v_pk_add_f32 v[110:111], v[110:111], v[80:81]
    v_pk_add_f32 v[112:113], v[112:113], v[82:83]
    v_pk_add_f32 v[146:147], v[146:147], v[84:85]
    v_pk_add_f32 v[148:149], v[148:149], v[86:87]
    v_pk_add_f32 v[236:237], v[236:237], v[88:89]
    v_pk_add_f32 v[238:239], v[238:239], v[90:91]
    s_waitcnt lgkmcnt(0)
    s_barrier
    v_pk_add_f32 v[122:123], v[122:123], v[92:93]
    v_pk_add_f32 v[124:125], v[124:125], v[94:95]
    v_pk_add_f32 v[158:159], v[158:159], v[96:97]
    v_pk_add_f32 v[160:161], v[160:161], v[98:99]
    v_pk_add_f32 v[26:27], v[26:27], v[100:101]
    v_pk_add_f32 v[28:29], v[28:29], v[102:103]
    v_max3_f32 v2, v110, v111, v112
    v_max3_f32 v2, v2, v113, v146
    v_max3_f32 v2, v2, v147, v148
    v_max3_f32 v2, v2, v149, v236
    v_max3_f32 v2, v2, v237, v238
    v_max_f32 v2, v2, v239
    v_max3_f32 v4, v122, v123, v124
    v_max3_f32 v4, v4, v125, v158
    v_max3_f32 v4, v4, v159, v160
    v_max3_f32 v4, v4, v161, v26
    v_max3_f32 v4, v4, v27, v28
    v_max_f32 v4, v4, v29
    v_mov_b32 v3, v2
    v_mov_b32 v5, v4
    s_nop 0
    v_permlane32_swap_b32 v2, v3
    v_permlane32_swap_b32 v4, v5
    v_max_f32 v2, v2, v3
    v_max_f32 v4, v4, v5
    v_mov_b32 v3, v2
    v_mov_b32 v5, v4
    s_nop 0
    v_permlane16_swap_b32 v2, v3
    v_permlane16_swap_b32 v4, v5
    v_max_f32 v2, v2, v3
    v_max_f32 v4, v4, v5
    v_mul_f32 v2, s57, v2
    v_mul_f32 v4, s57, v4
    s_mul_i32 s53, s60, 18432
    s_add_u32 s53, s53, 40960
    v_add_u32 v24, s53, v10
    v_add_u32 v25, s53, v13
    s_branch L_slow16
L_cont16:
    ds_read_b128 v[56:59], v22 offset:40960
    ds_read_b64_tr_b16 v[32:33], v16 offset:40960
    ds_read_b64_tr_b16 v[34:35], v16 offset:42240
    ds_read_b128 v[60:63], v22 offset:43008
    ds_read_b128 v[64:67], v22 offset:45056
    ds_read_b64_tr_b16 v[36:37], v18 offset:40992
    ds_read_b64_tr_b16 v[38:39], v18 offset:42272
    ds_read_b64_tr_b16 v[40:41], v16 offset:41024
    ds_read_b64_tr_b16 v[42:43], v16 offset:42304
    ds_read_b64_tr_b16 v[44:45], v18 offset:41056
    ds_read_b64_tr_b16 v[46:47], v18 offset:42336
    ds_read_b64_tr_b16 v[48:49], v16 offset:41088
    ds_read_b64_tr_b16 v[50:51], v16 offset:42368
    s_waitcnt lgkmcnt(0)
    v_mfma_f32_16x16x32_bf16 v[170:173], v[56:59], v[32:35], 0
    ds_read_b128 v[92:95], v23 offset:40960
    ds_read_b64_tr_b16 v[68:69], v16 offset:51200
    v_fma_f32 v110, v110, s57, -v2
    v_fma_f32 v111, v111, s57, -v2
    v_fma_f32 v112, v112, s57, -v2
    v_mfma_f32_16x16x32_bf16 v[174:177], v[60:63], v[32:35], 0
    ds_read_b64_tr_b16 v[70:71], v16 offset:52480
    ds_read_b128 v[96:99], v23 offset:43008
    v_fma_f32 v113, v113, s57, -v2
    v_fma_f32 v146, v146, s57, -v2
    v_fma_f32 v147, v147, s57, -v2
    v_mfma_f32_16x16x32_bf16 v[178:181], v[64:67], v[32:35], 0
    ds_read_b128 v[100:103], v23 offset:45056
    ds_read_b64_tr_b16 v[72:73], v18 offset:51232
    v_fma_f32 v148, v148, s57, -v2
    v_fma_f32 v149, v149, s57, -v2
    v_fma_f32 v236, v236, s57, -v2
    v_mfma_f32_16x16x32_bf16 v[188:191], v[56:59], v[36:39], 0
    ds_read_b64_tr_b16 v[74:75], v18 offset:52512
    v_fma_f32 v237, v237, s57, -v2
    v_fma_f32 v238, v238, s57, -v2
    v_fma_f32 v239, v239, s57, -v2
    v_mfma_f32_16x16x32_bf16 v[192:195], v[60:63], v[36:39], 0
    ds_read_b64_tr_b16 v[76:77], v16 offset:51264
    v_fma_f32 v122, v122, s57, -v4
    v_fma_f32 v123, v123, s57, -v4
    v_fma_f32 v124, v124, s57, -v4
    v_mfma_f32_16x16x32_bf16 v[196:199], v[64:67], v[36:39], 0
    ds_read_b64_tr_b16 v[78:79], v16 offset:52544
    v_fma_f32 v125, v125, s57, -v4
    v_fma_f32 v158, v158, s57, -v4
    v_fma_f32 v159, v159, s57, -v4
    v_mfma_f32_16x16x32_bf16 v[206:209], v[56:59], v[40:43], 0
    ds_read_b64_tr_b16 v[80:81], v18 offset:51296
    v_fma_f32 v160, v160, s57, -v4
    v_fma_f32 v161, v161, s57, -v4
    v_fma_f32 v26, v26, s57, -v4
    v_mfma_f32_16x16x32_bf16 v[210:213], v[60:63], v[40:43], 0
    ds_read_b64_tr_b16 v[82:83], v18 offset:52576
    v_fma_f32 v27, v27, s57, -v4
    v_fma_f32 v28, v28, s57, -v4
    v_fma_f32 v29, v29, s57, -v4
    v_mfma_f32_16x16x32_bf16 v[214:217], v[64:67], v[40:43], 0
    ds_read_b64_tr_b16 v[84:85], v16 offset:51328
    v_exp_f32 v110, v110
    v_exp_f32 v111, v111
    v_mfma_f32_16x16x32_bf16 v[224:227], v[56:59], v[44:47], 0
    ds_read_b64_tr_b16 v[86:87], v16 offset:52608
    v_exp_f32 v112, v112
    v_exp_f32 v113, v113
    v_mfma_f32_16x16x32_bf16 v[228:231], v[60:63], v[44:47], 0
    ds_read_b32 v15, v14 offset:272
    v_exp_f32 v146, v146
    v_exp_f32 v147, v147
    v_mfma_f32_16x16x32_bf16 v[232:235], v[64:67], v[44:47], 0
    v_exp_f32 v148, v148
    v_exp_f32 v149, v149
    v_mfma_f32_16x16x32_bf16 v[242:245], v[56:59], v[48:51], 0
    v_exp_f32 v236, v236
    v_exp_f32 v237, v237
    v_mfma_f32_16x16x32_bf16 v[246:249], v[60:63], v[48:51], 0
    v_exp_f32 v238, v238
    v_exp_f32 v239, v239
    v_mfma_f32_16x16x32_bf16 v[250:253], v[64:67], v[48:51], 0
    v_exp_f32 v122, v122
    v_exp_f32 v123, v123
    s_waitcnt lgkmcnt(0)
    v_cmp_ne_u32 vcc, 0, v15
    v_mfma_f32_16x16x32_bf16 v[170:173], v[92:95], v[68:71], v[170:173]
    s_cbranch_vccnz L_slow17
L_cont17:
    v_mfma_f32_16x16x32_bf16 v[174:177], v[96:99], v[68:71], v[174:177]
    ds_read_b128 v[56:59], v22 offset:0
    ds_read_b64_tr_b16 v[32:33], v16 offset:0
    v_exp_f32 v124, v124
    v_exp_f32 v125, v125
    v_mfma_f32_16x16x32_bf16 v[178:181], v[100:103], v[68:71], v[178:181]
    ds_read_b64_tr_b16 v[34:35], v16 offset:1280
    ds_read_b128 v[60:63], v22 offset:2048
    v_exp_f32 v158, v158
    v_exp_f32 v159, v159
    v_mfma_f32_16x16x32_bf16 v[188:191], v[92:95], v[72:75], v[188:191]
    ds_read_b128 v[64:67], v22 offset:4096
    ds_read_b64_tr_b16 v[36:37], v18 offset:32
    v_exp_f32 v160, v160
    v_exp_f32 v161, v161
    v_mfma_f32_16x16x32_bf16 v[192:195], v[96:99], v[72:75], v[192:195]
    ds_read_b64_tr_b16 v[38:39], v18 offset:1312
    v_exp_f32 v26, v26
    v_exp_f32 v27, v27
    v_mfma_f32_16x16x32_bf16 v[196:199], v[100:103], v[72:75], v[196:199]
    ds_read_b64_tr_b16 v[40:41], v16 offset:64
    v_exp_f32 v28, v28
    v_exp_f32 v29, v29
    v_mfma_f32_16x16x32_bf16 v[206:209], v[92:95], v[76:79], v[206:209]
    ds_read_b64_tr_b16 v[42:43], v16 offset:1344
    v_add_f32 v2, v110, v111
    v_add_f32 v2, v2, v112
    v_add_f32 v2, v2, v113
    v_mfma_f32_16x16x32_bf16 v[210:213], v[96:99], v[76:79], v[210:213]
    ds_read_b64_tr_b16 v[44:45], v18 offset:96
    v_add_f32 v2, v2, v146
    v_add_f32 v2, v2, v147
    v_add_f32 v2, v2, v148
    v_mfma_f32_16x16x32_bf16 v[214:217], v[100:103], v[76:79], v[214:217]
    ds_read_b64_tr_b16 v[46:47], v18 offset:1376
    v_add_f32 v2, v2, v149
    v_add_f32 v2, v2, v236
    v_add_f32 v2, v2, v237
    v_mfma_f32_16x16x32_bf16 v[224:227], v[92:95], v[80:83], v[224:227]
    ds_read_b64_tr_b16 v[48:49], v16 offset:128
    v_add_f32 v2, v2, v238
    v_add_f32 v2, v2, v239
    v_add_f32 v4, v122, v123
    v_mfma_f32_16x16x32_bf16 v[228:231], v[96:99], v[80:83], v[228:231]
    ds_read_b64_tr_b16 v[50:51], v16 offset:1408
    v_add_f32 v4, v4, v124
    v_add_f32 v4, v4, v125
    v_add_f32 v4, v4, v158
    v_mfma_f32_16x16x32_bf16 v[232:235], v[100:103], v[80:83], v[232:235]
    v_add_f32 v4, v4, v159
    v_add_f32 v4, v4, v160
    v_add_f32 v4, v4, v161
    v_mfma_f32_16x16x32_bf16 v[242:245], v[92:95], v[84:87], v[242:245]
    v_add_f32 v4, v4, v26
    v_add_f32 v4, v4, v27
    v_add_f32 v4, v4, v28
    v_mfma_f32_16x16x32_bf16 v[246:249], v[96:99], v[84:87], v[246:249]
    v_add_f32 v4, v4, v29
    v_mov_b32 v3, v2
    v_mov_b32 v5, v4
    v_mfma_f32_16x16x32_bf16 v[250:253], v[100:103], v[84:87], v[250:253]
    v_permlane32_swap_b32 v2, v3
    v_permlane32_swap_b32 v4, v5
    v_add_f32 v2, v2, v3
    s_waitcnt lgkmcnt(0)
    v_mfma_f32_16x16x32_bf16 v[170:173], v[56:59], v[32:35], v[170:173]
    ds_read_b128 v[92:95], v23 offset:0
    ds_read_b64_tr_b16 v[68:69], v16 offset:10240
    v_add_f32 v4, v4, v5
    v_mov_b32 v3, v2
    v_mov_b32 v5, v4
    v_mfma_f32_16x16x32_bf16 v[174:177], v[60:63], v[32:35], v[174:177]
    ds_read_b64_tr_b16 v[70:71], v16 offset:11520
    ds_read_b128 v[96:99], v23 offset:2048
    v_permlane16_swap_b32 v2, v3
    v_permlane16_swap_b32 v4, v5
    v_add_f32 v2, v2, v3
    v_mfma_f32_16x16x32_bf16 v[178:181], v[64:67], v[32:35], v[178:181]
    ds_read_b128 v[100:103], v23 offset:4096
    ds_read_b64_tr_b16 v[72:73], v18 offset:10272
    v_add_f32 v4, v4, v5
    v_rcp_f32 v2, v2
    v_mfma_f32_16x16x32_bf16 v[188:191], v[56:59], v[36:39], v[188:191]
    ds_read_b64_tr_b16 v[74:75], v18 offset:11552
    v_rcp_f32 v4, v4
    v_mul_f32 v110, v110, v2
    v_mfma_f32_16x16x32_bf16 v[192:195], v[60:63], v[36:39], v[192:195]
    ds_read_b64_tr_b16 v[76:77], v16 offset:10304
    v_mul_f32 v111, v111, v2
    v_mul_f32 v112, v112, v2
    v_mul_f32 v113, v113, v2
    v_mfma_f32_16x16x32_bf16 v[196:199], v[64:67], v[36:39], v[196:199]
    ds_read_b64_tr_b16 v[78:79], v16 offset:11584
    v_mul_f32 v146, v146, v2
    v_mul_f32 v147, v147, v2
    v_mul_f32 v148, v148, v2
    v_mfma_f32_16x16x32_bf16 v[206:209], v[56:59], v[40:43], v[206:209]
    ds_read_b64_tr_b16 v[80:81], v18 offset:10336
    v_mul_f32 v149, v149, v2
    v_mul_f32 v236, v236, v2
    v_mul_f32 v237, v237, v2
    v_mfma_f32_16x16x32_bf16 v[210:213], v[60:63], v[40:43], v[210:213]
    ds_read_b64_tr_b16 v[82:83], v18 offset:11616
    v_mul_f32 v238, v238, v2
    v_mul_f32 v239, v239, v2
    v_cvt_pk_bf16_f32 v110, v110, v111
    v_mfma_f32_16x16x32_bf16 v[214:217], v[64:67], v[40:43], v[214:217]
    ds_read_b64_tr_b16 v[84:85], v16 offset:10368
    v_cvt_pk_bf16_f32 v111, v112, v113
    v_cvt_pk_bf16_f32 v112, v146, v147
    v_cvt_pk_bf16_f32 v113, v148, v149
    v_mfma_f32_16x16x32_bf16 v[224:227], v[56:59], v[44:47], v[224:227]
    ds_read_b64_tr_b16 v[86:87], v16 offset:11648
    v_cvt_pk_bf16_f32 v146, v236, v237
    v_cvt_pk_bf16_f32 v147, v238, v239
    v_mul_f32 v122, v122, v4
    v_mfma_f32_16x16x32_bf16 v[228:231], v[60:63], v[44:47], v[228:231]
    ds_read_b32 v15, v14 offset:288
    v_mul_f32 v123, v123, v4
    v_mul_f32 v124, v124, v4
    v_mul_f32 v125, v125, v4
    v_mfma_f32_16x16x32_bf16 v[232:235], v[64:67], v[44:47], v[232:235]
    v_mul_f32 v158, v158, v4
    v_mul_f32 v159, v159, v4
    v_mul_f32 v160, v160, v4
    v_mfma_f32_16x16x32_bf16 v[242:245], v[56:59], v[48:51], v[242:245]
    v_mul_f32 v161, v161, v4
    v_mul_f32 v26, v26, v4
    v_mul_f32 v27, v27, v4
    v_mfma_f32_16x16x32_bf16 v[246:249], v[60:63], v[48:51], v[246:249]
    v_mul_f32 v28, v28, v4
    v_mul_f32 v29, v29, v4
    v_cvt_pk_bf16_f32 v122, v122, v123
    v_mfma_f32_16x16x32_bf16 v[250:253], v[64:67], v[48:51], v[250:253]
    v_cvt_pk_bf16_f32 v123, v124, v125
    v_cvt_pk_bf16_f32 v124, v158, v159
    v_cvt_pk_bf16_f32 v125, v160, v161
    s_waitcnt lgkmcnt(0)
    v_cmp_ne_u32 vcc, 0, v15
    v_mfma_f32_16x16x32_bf16 v[170:173], v[92:95], v[68:71], v[170:173]
    s_barrier
    s_cbranch_vccnz L_slow18
L_cont18:
    v_mfma_f32_16x16x32_bf16 v[174:177], v[96:99], v[68:71], v[174:177]
    ds_read_b128 v[56:59], v30 offset:40960
    ds_read_b64_tr_b16 v[32:33], v17 offset:40960
    v_cvt_pk_bf16_f32 v158, v26, v27
    v_cvt_pk_bf16_f32 v159, v28, v29
    v_mfma_f32_16x16x32_bf16 v[178:181], v[100:103], v[68:71], v[178:181]
    ds_read_b64_tr_b16 v[34:35], v17 offset:42240
    ds_read_b128 v[60:63], v30 offset:43008
    v_mfma_f32_16x16x32_bf16 v[188:191], v[92:95], v[72:75], v[188:191]
    ds_read_b128 v[64:67], v30 offset:45056
    ds_read_b64_tr_b16 v[36:37], v19 offset:40992
    v_mfma_f32_16x16x32_bf16 v[192:195], v[96:99], v[72:75], v[192:195]
    ds_read_b64_tr_b16 v[38:39], v19 offset:42272
    v_mfma_f32_16x16x32_bf16 v[196:199], v[100:103], v[72:75], v[196:199]
    ds_read_b64_tr_b16 v[40:41], v17 offset:41024
    v_mfma_f32_16x16x32_bf16 v[206:209], v[92:95], v[76:79], v[206:209]
    ds_read_b64_tr_b16 v[42:43], v17 offset:42304
    v_mfma_f32_16x16x32_bf16 v[210:213], v[96:99], v[76:79], v[210:213]
    ds_read_b64_tr_b16 v[44:45], v19 offset:41056
    v_mfma_f32_16x16x32_bf16 v[214:217], v[100:103], v[76:79], v[214:217]
    ds_read_b64_tr_b16 v[46:47], v19 offset:42336
    v_mfma_f32_16x16x32_bf16 v[224:227], v[92:95], v[80:83], v[224:227]
    ds_read_b64_tr_b16 v[48:49], v17 offset:41088
    v_mfma_f32_16x16x32_bf16 v[228:231], v[96:99], v[80:83], v[228:231]
    ds_read_b64_tr_b16 v[50:51], v17 offset:42368
    v_mfma_f32_16x16x32_bf16 v[232:235], v[100:103], v[80:83], v[232:235]
    v_mfma_f32_16x16x32_bf16 v[242:245], v[92:95], v[84:87], v[242:245]
    v_mfma_f32_16x16x32_bf16 v[246:249], v[96:99], v[84:87], v[246:249]
    v_mfma_f32_16x16x32_bf16 v[250:253], v[100:103], v[84:87], v[250:253]
    s_lshl_b32 s53, s61, 10
    s_add_u32 s54, s53, s66
    s_add_u32 s53, s53, s54
    buffer_store_dwordx4 v[110:113], v10, s[44:47], s53 offen sc1
    buffer_store_dwordx2 v[146:147], v13, s[44:47], s54 offen offset:2560 sc1
    s_cmp_lg_u32 s61, 0
    s_cbranch_scc1 L_pp1
    buffer_store_dwordx4 v[122:125], v10, s[44:47], s66 offen offset:1024 sc1
L_ppd:
    s_waitcnt lgkmcnt(0)
    v_mfma_f32_16x16x32_bf16 v[170:173], v[56:59], v[32:35], v[170:173]
    ds_read_b128 v[92:95], v31 offset:40960
    ds_read_b64_tr_b16 v[68:69], v17 offset:51200
    v_mfma_f32_16x16x32_bf16 v[174:177], v[60:63], v[32:35], v[174:177]
    ds_read_b64_tr_b16 v[70:71], v17 offset:52480
    ds_read_b128 v[96:99], v31 offset:43008
    v_mfma_f32_16x16x32_bf16 v[178:181], v[64:67], v[32:35], v[178:181]
    ds_read_b128 v[100:103], v31 offset:45056
    ds_read_b64_tr_b16 v[72:73], v19 offset:51232
    v_mfma_f32_16x16x32_bf16 v[188:191], v[56:59], v[36:39], v[188:191]
    ds_read_b64_tr_b16 v[74:75], v19 offset:52512
    v_mfma_f32_16x16x32_bf16 v[192:195], v[60:63], v[36:39], v[192:195]
    ds_read_b64_tr_b16 v[76:77], v17 offset:51264
    v_mfma_f32_16x16x32_bf16 v[196:199], v[64:67], v[36:39], v[196:199]
    ds_read_b64_tr_b16 v[78:79], v17 offset:52544
    v_mfma_f32_16x16x32_bf16 v[206:209], v[56:59], v[40:43], v[206:209]
    ds_read_b64_tr_b16 v[80:81], v19 offset:51296
    v_mfma_f32_16x16x32_bf16 v[210:213], v[60:63], v[40:43], v[210:213]
    ds_read_b64_tr_b16 v[82:83], v19 offset:52576
    v_mfma_f32_16x16x32_bf16 v[214:217], v[64:67], v[40:43], v[214:217]
    ds_read_b64_tr_b16 v[84:85], v17 offset:51328
    v_mfma_f32_16x16x32_bf16 v[224:227], v[56:59], v[44:47], v[224:227]
    ds_read_b64_tr_b16 v[86:87], v17 offset:52608
    v_mfma_f32_16x16x32_bf16 v[228:231], v[60:63], v[44:47], v[228:231]
    ds_read_b32 v15, v14 offset:304
    v_mfma_f32_16x16x32_bf16 v[232:235], v[64:67], v[44:47], v[232:235]
    v_mfma_f32_16x16x32_bf16 v[242:245], v[56:59], v[48:51], v[242:245]
    v_mfma_f32_16x16x32_bf16 v[246:249], v[60:63], v[48:51], v[246:249]
    v_mfma_f32_16x16x32_bf16 v[250:253], v[64:67], v[48:51], v[250:253]
    s_waitcnt lgkmcnt(0)
    v_cmp_ne_u32 vcc, 0, v15
    v_mfma_f32_16x16x32_bf16 v[170:173], v[92:95], v[68:71], v[170:173]
    s_cbranch_vccnz L_slow19
L_cont19:
    v_mfma_f32_16x16x32_bf16 v[174:177], v[96:99], v[68:71], v[174:177]
    ds_read_b128 v[56:59], v30 offset:0
    ds_read_b64_tr_b16 v[32:33], v17 offset:0
    v_mfma_f32_16x16x32_bf16 v[178:181], v[100:103], v[68:71], v[178:181]
    ds_read_b64_tr_b16 v[34:35], v17 offset:1280
    ds_read_b128 v[60:63], v30 offset:2048
    v_mfma_f32_16x16x32_bf16 v[188:191], v[92:95], v[72:75], v[188:191]
    ds_read_b128 v[64:67], v30 offset:4096
    ds_read_b64_tr_b16 v[36:37], v19 offset:32
    v_mfma_f32_16x16x32_bf16 v[192:195], v[96:99], v[72:75], v[192:195]
    ds_read_b64_tr_b16 v[38:39], v19 offset:1312
    v_mfma_f32_16x16x32_bf16 v[196:199], v[100:103], v[72:75], v[196:199]
    ds_read_b64_tr_b16 v[40:41], v17 offset:64
    v_mfma_f32_16x16x32_bf16 v[206:209], v[92:95], v[76:79], v[206:209]
    ds_read_b64_tr_b16 v[42:43], v17 offset:1344
    v_cvt_pk_bf16_f32 v104, v170, v171
    v_cvt_pk_bf16_f32 v105, v172, v173
    v_mfma_f32_16x16x32_bf16 v[210:213], v[96:99], v[76:79], v[210:213]
    ds_read_b64_tr_b16 v[44:45], v19 offset:96
    v_cvt_pk_bf16_f32 v106, v174, v175
    v_cvt_pk_bf16_f32 v107, v176, v177
    v_mfma_f32_16x16x32_bf16 v[214:217], v[100:103], v[76:79], v[214:217]
    ds_read_b64_tr_b16 v[46:47], v19 offset:1376
    v_cvt_pk_bf16_f32 v108, v178, v179
    v_cvt_pk_bf16_f32 v109, v180, v181
    v_mfma_f32_16x16x32_bf16 v[224:227], v[92:95], v[80:83], v[224:227]
    ds_read_b64_tr_b16 v[48:49], v17 offset:128
    v_cvt_pk_bf16_f32 v116, v188, v189
    v_cvt_pk_bf16_f32 v117, v190, v191
    v_mfma_f32_16x16x32_bf16 v[228:231], v[96:99], v[80:83], v[228:231]
    ds_read_b64_tr_b16 v[50:51], v17 offset:1408
    v_cvt_pk_bf16_f32 v118, v192, v193
    v_cvt_pk_bf16_f32 v119, v194, v195
    v_mfma_f32_16x16x32_bf16 v[232:235], v[100:103], v[80:83], v[232:235]
    v_cvt_pk_bf16_f32 v120, v196, v197
    v_cvt_pk_bf16_f32 v121, v198, v199
    v_mfma_f32_16x16x32_bf16 v[242:245], v[92:95], v[84:87], v[242:245]
    v_cvt_pk_bf16_f32 v128, v206, v207
    v_cvt_pk_bf16_f32 v129, v208, v209
    v_mfma_f32_16x16x32_bf16 v[246:249], v[96:99], v[84:87], v[246:249]
    v_cvt_pk_bf16_f32 v130, v210, v211
    v_cvt_pk_bf16_f32 v131, v212, v213
    v_mfma_f32_16x16x32_bf16 v[250:253], v[100:103], v[84:87], v[250:253]
    v_cvt_pk_bf16_f32 v132, v214, v215
    v_cvt_pk_bf16_f32 v133, v216, v217
    s_waitcnt lgkmcnt(0)
    v_mfma_f32_16x16x32_bf16 v[170:173], v[56:59], v[32:35], 0
    s_waitcnt vmcnt(0)
    buffer_store_dword v20, v21, s[44:47], s65 offen sc1
    v_mfma_f32_16x16x32_bf16 v[174:177], v[60:63], v[32:35], 0
    ds_read_b128 v[92:95], v31 offset:0
    ds_read_b64_tr_b16 v[68:69], v17 offset:10240
    v_cvt_pk_bf16_f32 v140, v224, v225
    v_cvt_pk_bf16_f32 v141, v226, v227
    v_mfma_f32_16x16x32_bf16 v[178:181], v[64:67], v[32:35], 0
    ds_read_b64_tr_b16 v[70:71], v17 offset:11520
    ds_read_b128 v[96:99], v31 offset:2048
    v_cvt_pk_bf16_f32 v142, v228, v229
    v_cvt_pk_bf16_f32 v143, v230, v231
    v_mfma_f32_16x16x32_bf16 v[188:191], v[56:59], v[36:39], 0
    ds_read_b128 v[100:103], v31 offset:4096
    ds_read_b64_tr_b16 v[72:73], v19 offset:10272
    v_cvt_pk_bf16_f32 v144, v232, v233
    v_cvt_pk_bf16_f32 v145, v234, v235
    v_mfma_f32_16x16x32_bf16 v[192:195], v[60:63], v[36:39], 0
    ds_read_b64_tr_b16 v[74:75], v19 offset:11552
    v_cvt_pk_bf16_f32 v152, v242, v243
    v_cvt_pk_bf16_f32 v153, v244, v245
    v_mfma_f32_16x16x32_bf16 v[196:199], v[64:67], v[36:39], 0
    ds_read_b64_tr_b16 v[76:77], v17 offset:10304
    v_cvt_pk_bf16_f32 v154, v246, v247
    v_cvt_pk_bf16_f32 v155, v248, v249
    v_mfma_f32_16x16x32_bf16 v[206:209], v[56:59], v[40:43], 0
    ds_read_b64_tr_b16 v[78:79], v17 offset:11584
    v_cvt_pk_bf16_f32 v156, v250, v251
    v_cvt_pk_bf16_f32 v157, v252, v253
    v_mfma_f32_16x16x32_bf16 v[210:213], v[60:63], v[40:43], 0
    ds_read_b64_tr_b16 v[80:81], v19 offset:10336
    v_mfma_f32_16x16x32_bf16 v[214:217], v[64:67], v[40:43], 0
    ds_read_b64_tr_b16 v[82:83], v19 offset:11616
    v_mfma_f32_16x16x32_bf16 v[224:227], v[56:59], v[44:47], 0
    ds_read_b64_tr_b16 v[84:85], v17 offset:10368
    v_mfma_f32_16x16x32_bf16 v[228:231], v[60:63], v[44:47], 0
    ds_read_b64_tr_b16 v[86:87], v17 offset:11648
    v_mfma_f32_16x16x32_bf16 v[232:235], v[64:67], v[44:47], 0
    ds_read_b32 v15, v14 offset:320
    v_mfma_f32_16x16x32_bf16 v[242:245], v[56:59], v[48:51], 0
    v_mfma_f32_16x16x32_bf16 v[246:249], v[60:63], v[48:51], 0
    v_mfma_f32_16x16x32_bf16 v[250:253], v[64:67], v[48:51], 0
    s_waitcnt lgkmcnt(0)
    v_cmp_ne_u32 vcc, 0, v15
    v_mfma_f32_16x16x32_bf16 v[170:173], v[92:95], v[68:71], v[170:173]
    s_barrier
    s_cbranch_vccnz L_slow20
L_cont20:
    v_mfma_f32_16x16x32_bf16 v[174:177], v[96:99], v[68:71], v[174:177]
    ds_read_b128 v[56:59], v22 offset:40960
    ds_read_b64_tr_b16 v[32:33], v16 offset:40960
    v_mfma_f32_16x16x32_bf16 v[178:181], v[100:103], v[68:71], v[178:181]
    ds_read_b64_tr_b16 v[34:35], v16 offset:42240
    ds_read_b128 v[60:63], v22 offset:43008
    v_mfma_f32_16x16x32_bf16 v[188:191], v[92:95], v[72:75], v[188:191]
    ds_read_b128 v[64:67], v22 offset:45056
    ds_read_b64_tr_b16 v[36:37], v18 offset:40992
    v_mfma_f32_16x16x32_bf16 v[192:195], v[96:99], v[72:75], v[192:195]
    ds_read_b64_tr_b16 v[38:39], v18 offset:42272
    v_mfma_f32_16x16x32_bf16 v[196:199], v[100:103], v[72:75], v[196:199]
    ds_read_b64_tr_b16 v[40:41], v16 offset:41024
    v_mfma_f32_16x16x32_bf16 v[206:209], v[92:95], v[76:79], v[206:209]
    ds_read_b64_tr_b16 v[42:43], v16 offset:42304
    v_mfma_f32_16x16x32_bf16 v[210:213], v[96:99], v[76:79], v[210:213]
    ds_read_b64_tr_b16 v[44:45], v18 offset:41056
    v_mfma_f32_16x16x32_bf16 v[214:217], v[100:103], v[76:79], v[214:217]
    ds_read_b64_tr_b16 v[46:47], v18 offset:42336
    v_mfma_f32_16x16x32_bf16 v[224:227], v[92:95], v[80:83], v[224:227]
    ds_read_b64_tr_b16 v[48:49], v16 offset:41088
    v_mfma_f32_16x16x32_bf16 v[228:231], v[96:99], v[80:83], v[228:231]
    ds_read_b64_tr_b16 v[50:51], v16 offset:42368
    v_mfma_f32_16x16x32_bf16 v[232:235], v[100:103], v[80:83], v[232:235]
    v_mfma_f32_16x16x32_bf16 v[242:245], v[92:95], v[84:87], v[242:245]
    v_mfma_f32_16x16x32_bf16 v[246:249], v[96:99], v[84:87], v[246:249]
    v_mfma_f32_16x16x32_bf16 v[250:253], v[100:103], v[84:87], v[250:253]
    s_waitcnt lgkmcnt(0)
    v_mfma_f32_16x16x32_bf16 v[170:173], v[56:59], v[32:35], v[170:173]
    ds_read_b128 v[92:95], v23 offset:40960
    ds_read_b64_tr_b16 v[68:69], v16 offset:51200
    v_mfma_f32_16x16x32_bf16 v[174:177], v[60:63], v[32:35], v[174:177]
    ds_read_b64_tr_b16 v[70:71], v16 offset:52480
    ds_read_b128 v[96:99], v23 offset:43008
    v_mfma_f32_16x16x32_bf16 v[178:181], v[64:67], v[32:35], v[178:181]
    ds_read_b128 v[100:103], v23 offset:45056
    ds_read_b64_tr_b16 v[72:73], v18 offset:51232
    v_mfma_f32_16x16x32_bf16 v[188:191], v[56:59], v[36:39], v[188:191]
    ds_read_b64_tr_b16 v[74:75], v18 offset:52512
    v_mfma_f32_16x16x32_bf16 v[192:195], v[60:63], v[36:39], v[192:195]
    ds_read_b64_tr_b16 v[76:77], v16 offset:51264
    v_mfma_f32_16x16x32_bf16 v[196:199], v[64:67], v[36:39], v[196:199]
    ds_read_b64_tr_b16 v[78:79], v16 offset:52544
    v_mfma_f32_16x16x32_bf16 v[206:209], v[56:59], v[40:43], v[206:209]
    ds_read_b64_tr_b16 v[80:81], v18 offset:51296
    v_mfma_f32_16x16x32_bf16 v[210:213], v[60:63], v[40:43], v[210:213]
    ds_read_b64_tr_b16 v[82:83], v18 offset:52576
    v_mfma_f32_16x16x32_bf16 v[214:217], v[64:67], v[40:43], v[214:217]
    ds_read_b64_tr_b16 v[84:85], v16 offset:51328
    v_mfma_f32_16x16x32_bf16 v[224:227], v[56:59], v[44:47], v[224:227]
    ds_read_b64_tr_b16 v[86:87], v16 offset:52608
    v_mfma_f32_16x16x32_bf16 v[228:231], v[60:63], v[44:47], v[228:231]
    ds_read_b32 v15, v14 offset:336
    v_mfma_f32_16x16x32_bf16 v[232:235], v[64:67], v[44:47], v[232:235]
    v_mfma_f32_16x16x32_bf16 v[242:245], v[56:59], v[48:51], v[242:245]
    v_mfma_f32_16x16x32_bf16 v[246:249], v[60:63], v[48:51], v[246:249]
    v_mfma_f32_16x16x32_bf16 v[250:253], v[64:67], v[48:51], v[250:253]
    s_waitcnt lgkmcnt(0)
    v_cmp_ne_u32 vcc, 0, v15
    v_mfma_f32_16x16x32_bf16 v[170:173], v[92:95], v[68:71], v[170:173]
    s_cbranch_vccnz L_slow21
L_cont21:
    v_mfma_f32_16x16x32_bf16 v[174:177], v[96:99], v[68:71], v[174:177]
    ds_read_b128 v[56:59], v22 offset:0
    ds_read_b64_tr_b16 v[32:33], v16 offset:0
    v_mfma_f32_16x16x32_bf16 v[178:181], v[100:103], v[68:71], v[178:181]
    ds_read_b64_tr_b16 v[34:35], v16 offset:1280
    ds_read_b128 v[60:63], v22 offset:2048
    v_mfma_f32_16x16x32_bf16 v[188:191], v[92:95], v[72:75], v[188:191]
    ds_read_b128 v[64:67], v22 offset:4096
    ds_read_b64_tr_b16 v[36:37], v18 offset:32
    v_mfma_f32_16x16x32_bf16 v[192:195], v[96:99], v[72:75], v[192:195]
    ds_read_b64_tr_b16 v[38:39], v18 offset:1312
    v_mfma_f32_16x16x32_bf16 v[196:199], v[100:103], v[72:75], v[196:199]
    ds_read_b64_tr_b16 v[40:41], v16 offset:64
    v_mfma_f32_16x16x32_bf16 v[206:209], v[92:95], v[76:79], v[206:209]
    ds_read_b64_tr_b16 v[42:43], v16 offset:1344
    v_mfma_f32_16x16x32_bf16 v[210:213], v[96:99], v[76:79], v[210:213]
    ds_read_b64_tr_b16 v[44:45], v18 offset:96
    v_mfma_f32_16x16x32_bf16 v[214:217], v[100:103], v[76:79], v[214:217]
    ds_read_b64_tr_b16 v[46:47], v18 offset:1376
    v_mfma_f32_16x16x32_bf16 v[224:227], v[92:95], v[80:83], v[224:227]
    ds_read_b64_tr_b16 v[48:49], v16 offset:128
    v_mfma_f32_16x16x32_bf16 v[228:231], v[96:99], v[80:83], v[228:231]
    ds_read_b64_tr_b16 v[50:51], v16 offset:1408
    v_mfma_f32_16x16x32_bf16 v[232:235], v[100:103], v[80:83], v[232:235]
    v_mfma_f32_16x16x32_bf16 v[242:245], v[92:95], v[84:87], v[242:245]
    v_mfma_f32_16x16x32_bf16 v[246:249], v[96:99], v[84:87], v[246:249]
    v_mfma_f32_16x16x32_bf16 v[250:253], v[100:103], v[84:87], v[250:253]
    s_waitcnt lgkmcnt(0)
    v_mfma_f32_16x16x32_bf16 v[170:173], v[56:59], v[32:35], v[170:173]
    ds_read_b128 v[92:95], v23 offset:0
    ds_read_b64_tr_b16 v[68:69], v16 offset:10240
    v_mfma_f32_16x16x32_bf16 v[174:177], v[60:63], v[32:35], v[174:177]
    ds_read_b64_tr_b16 v[70:71], v16 offset:11520
    ds_read_b128 v[96:99], v23 offset:2048
    v_mfma_f32_16x16x32_bf16 v[178:181], v[64:67], v[32:35], v[178:181]
    ds_read_b128 v[100:103], v23 offset:4096
    ds_read_b64_tr_b16 v[72:73], v18 offset:10272
    v_mfma_f32_16x16x32_bf16 v[188:191], v[56:59], v[36:39], v[188:191]
    ds_read_b64_tr_b16 v[74:75], v18 offset:11552
    v_mfma_f32_16x16x32_bf16 v[192:195], v[60:63], v[36:39], v[192:195]
    ds_read_b64_tr_b16 v[76:77], v16 offset:10304
    v_mfma_f32_16x16x32_bf16 v[196:199], v[64:67], v[36:39], v[196:199]
    ds_read_b64_tr_b16 v[78:79], v16 offset:11584
    v_mfma_f32_16x16x32_bf16 v[206:209], v[56:59], v[40:43], v[206:209]
    ds_read_b64_tr_b16 v[80:81], v18 offset:10336
    v_mfma_f32_16x16x32_bf16 v[210:213], v[60:63], v[40:43], v[210:213]
    ds_read_b64_tr_b16 v[82:83], v18 offset:11616
    v_mfma_f32_16x16x32_bf16 v[214:217], v[64:67], v[40:43], v[214:217]
    ds_read_b64_tr_b16 v[84:85], v16 offset:10368
    v_mfma_f32_16x16x32_bf16 v[224:227], v[56:59], v[44:47], v[224:227]
    ds_read_b64_tr_b16 v[86:87], v16 offset:11648
    v_mfma_f32_16x16x32_bf16 v[228:231], v[60:63], v[44:47], v[228:231]
    ds_read_b32 v15, v14 offset:352
    v_mfma_f32_16x16x32_bf16 v[232:235], v[64:67], v[44:47], v[232:235]
    v_mfma_f32_16x16x32_bf16 v[242:245], v[56:59], v[48:51], v[242:245]
    v_mfma_f32_16x16x32_bf16 v[246:249], v[60:63], v[48:51], v[246:249]
    v_mfma_f32_16x16x32_bf16 v[250:253], v[64:67], v[48:51], v[250:253]
    s_waitcnt lgkmcnt(0)
    v_cmp_ne_u32 vcc, 0, v15
    v_mfma_f32_16x16x32_bf16 v[170:173], v[92:95], v[68:71], v[170:173]
    s_barrier
    s_cbranch_vccnz L_slow22
L_cont22:
    v_mfma_f32_16x16x32_bf16 v[174:177], v[96:99], v[68:71], v[174:177]
    ds_read_b128 v[56:59], v30 offset:40960
    ds_read_b64_tr_b16 v[32:33], v17 offset:40960
    v_mfma_f32_16x16x32_bf16 v[178:181], v[100:103], v[68:71], v[178:181]
    ds_read_b64_tr_b16 v[34:35], v17 offset:42240
    ds_read_b128 v[60:63], v30 offset:43008
    v_mfma_f32_16x16x32_bf16 v[188:191], v[92:95], v[72:75], v[188:191]
    ds_read_b128 v[64:67], v30 offset:45056
    ds_read_b64_tr_b16 v[36:37], v19 offset:40992
    v_mfma_f32_16x16x32_bf16 v[192:195], v[96:99], v[72:75], v[192:195]
    ds_read_b64_tr_b16 v[38:39], v19 offset:42272
    v_mfma_f32_16x16x32_bf16 v[196:199], v[100:103], v[72:75], v[196:199]
    ds_read_b64_tr_b16 v[40:41], v17 offset:41024
    v_mfma_f32_16x16x32_bf16 v[206:209], v[92:95], v[76:79], v[206:209]
    ds_read_b64_tr_b16 v[42:43], v17 offset:42304
    v_cvt_pk_bf16_f32 v110, v170, v171
    v_cvt_pk_bf16_f32 v111, v172, v173
    v_mfma_f32_16x16x32_bf16 v[210:213], v[96:99], v[76:79], v[210:213]
    ds_read_b64_tr_b16 v[44:45], v19 offset:41056
    v_cvt_pk_bf16_f32 v112, v174, v175
    v_cvt_pk_bf16_f32 v113, v176, v177
    v_mfma_f32_16x16x32_bf16 v[214:217], v[100:103], v[76:79], v[214:217]
    ds_read_b64_tr_b16 v[46:47], v19 offset:42336
    v_cvt_pk_bf16_f32 v114, v178, v179
    v_cvt_pk_bf16_f32 v115, v180, v181
    v_mfma_f32_16x16x32_bf16 v[224:227], v[92:95], v[80:83], v[224:227]
    ds_read_b64_tr_b16 v[48:49], v17 offset:41088
    v_cvt_pk_bf16_f32 v122, v188, v189
    v_cvt_pk_bf16_f32 v123, v190, v191
    v_mfma_f32_16x16x32_bf16 v[228:231], v[96:99], v[80:83], v[228:231]
    ds_read_b64_tr_b16 v[50:51], v17 offset:42368
    v_cvt_pk_bf16_f32 v124, v192, v193
    v_cvt_pk_bf16_f32 v125, v194, v195
    v_mfma_f32_16x16x32_bf16 v[232:235], v[100:103], v[80:83], v[232:235]
    v_cvt_pk_bf16_f32 v126, v196, v197
    v_cvt_pk_bf16_f32 v127, v198, v199
    v_mfma_f32_16x16x32_bf16 v[242:245], v[92:95], v[84:87], v[242:245]
    v_cvt_pk_bf16_f32 v134, v206, v207
    v_cvt_pk_bf16_f32 v135, v208, v209
    v_mfma_f32_16x16x32_bf16 v[246:249], v[96:99], v[84:87], v[246:249]
    v_cvt_pk_bf16_f32 v136, v210, v211
    v_cvt_pk_bf16_f32 v137, v212, v213
    v_mfma_f32_16x16x32_bf16 v[250:253], v[100:103], v[84:87], v[250:253]
    v_cvt_pk_bf16_f32 v138, v214, v215
    v_cvt_pk_bf16_f32 v139, v216, v217
    s_waitcnt lgkmcnt(0)
    v_mfma_f32_16x16x32_bf16 v[170:173], v[56:59], v[32:35], 0
    ds_read_b128 v[92:95], v31 offset:40960
    ds_read_b64_tr_b16 v[68:69], v17 offset:51200
    v_cvt_pk_bf16_f32 v146, v224, v225
    v_cvt_pk_bf16_f32 v147, v226, v227
    v_mfma_f32_16x16x32_bf16 v[174:177], v[60:63], v[32:35], 0
    ds_read_b64_tr_b16 v[70:71], v17 offset:52480
    ds_read_b128 v[96:99], v31 offset:43008
    v_cvt_pk_bf16_f32 v148, v228, v229
    v_cvt_pk_bf16_f32 v149, v230, v231
    v_mfma_f32_16x16x32_bf16 v[178:181], v[64:67], v[32:35], 0
    ds_read_b128 v[100:103], v31 offset:45056
    ds_read_b64_tr_b16 v[72:73], v19 offset:51232
    v_cvt_pk_bf16_f32 v150, v232, v233
    v_cvt_pk_bf16_f32 v151, v234, v235
    v_mfma_f32_16x16x32_bf16 v[188:191], v[56:59], v[36:39], 0
    ds_read_b64_tr_b16 v[74:75], v19 offset:52512
    v_cvt_pk_bf16_f32 v158, v242, v243
    v_cvt_pk_bf16_f32 v159, v244, v245
    v_mfma_f32_16x16x32_bf16 v[192:195], v[60:63], v[36:39], 0
    ds_read_b64_tr_b16 v[76:77], v17 offset:51264
    v_cvt_pk_bf16_f32 v160, v246, v247
    v_cvt_pk_bf16_f32 v161, v248, v249
    v_mfma_f32_16x16x32_bf16 v[196:199], v[64:67], v[36:39], 0
    ds_read_b64_tr_b16 v[78:79], v17 offset:52544
    v_cvt_pk_bf16_f32 v162, v250, v251
    v_cvt_pk_bf16_f32 v163, v252, v253
    v_mfma_f32_16x16x32_bf16 v[206:209], v[56:59], v[40:43], 0
    ds_read_b64_tr_b16 v[80:81], v19 offset:51296
    v_mfma_f32_16x16x32_bf16 v[210:213], v[60:63], v[40:43], 0
    ds_read_b64_tr_b16 v[82:83], v19 offset:52576
    v_mfma_f32_16x16x32_bf16 v[214:217], v[64:67], v[40:43], 0
    ds_read_b64_tr_b16 v[84:85], v17 offset:51328
    v_mfma_f32_16x16x32_bf16 v[224:227], v[56:59], v[44:47], 0
    ds_read_b64_tr_b16 v[86:87], v17 offset:52608
    v_mfma_f32_16x16x32_bf16 v[228:231], v[60:63], v[44:47], 0
    ds_read_b32 v15, v14 offset:368
    v_mfma_f32_16x16x32_bf16 v[232:235], v[64:67], v[44:47], 0
    v_mfma_f32_16x16x32_bf16 v[242:245], v[56:59], v[48:51], 0
    v_mfma_f32_16x16x32_bf16 v[246:249], v[60:63], v[48:51], 0
    v_mfma_f32_16x16x32_bf16 v[250:253], v[64:67], v[48:51], 0
    s_waitcnt lgkmcnt(0)
    v_cmp_ne_u32 vcc, 0, v15
    v_mfma_f32_16x16x32_bf16 v[170:173], v[92:95], v[68:71], v[170:173]
    s_barrier
    s_cbranch_vccnz L_slow23
L_cont23:
    v_mfma_f32_16x16x32_bf16 v[174:177], v[96:99], v[68:71], v[174:177]
    ds_read_b128 v[56:59], v30 offset:0
    ds_read_b64_tr_b16 v[32:33], v17 offset:0
    v_mfma_f32_16x16x32_bf16 v[178:181], v[100:103], v[68:71], v[178:181]
    ds_read_b64_tr_b16 v[34:35], v17 offset:1280
    ds_read_b128 v[60:63], v30 offset:2048
    v_mfma_f32_16x16x32_bf16 v[188:191], v[92:95], v[72:75], v[188:191]
    ds_read_b128 v[64:67], v30 offset:4096
    ds_read_b64_tr_b16 v[36:37], v19 offset:32
    v_mfma_f32_16x16x32_bf16 v[192:195], v[96:99], v[72:75], v[192:195]
    ds_read_b64_tr_b16 v[38:39], v19 offset:1312
    v_mfma_f32_16x16x32_bf16 v[196:199], v[100:103], v[72:75], v[196:199]
    ds_read_b64_tr_b16 v[40:41], v17 offset:64
    v_mfma_f32_16x16x32_bf16 v[206:209], v[92:95], v[76:79], v[206:209]
    ds_read_b64_tr_b16 v[42:43], v17 offset:1344
    v_mfma_f32_16x16x32_bf16 v[210:213], v[96:99], v[76:79], v[210:213]
    ds_read_b64_tr_b16 v[44:45], v19 offset:96
    v_mfma_f32_16x16x32_bf16 v[214:217], v[100:103], v[76:79], v[214:217]
    ds_read_b64_tr_b16 v[46:47], v19 offset:1376
    v_mfma_f32_16x16x32_bf16 v[224:227], v[92:95], v[80:83], v[224:227]
    ds_read_b64_tr_b16 v[48:49], v17 offset:128
    v_mfma_f32_16x16x32_bf16 v[228:231], v[96:99], v[80:83], v[228:231]
    ds_read_b64_tr_b16 v[50:51], v17 offset:1408
    v_mfma_f32_16x16x32_bf16 v[232:235], v[100:103], v[80:83], v[232:235]
    v_mfma_f32_16x16x32_bf16 v[242:245], v[92:95], v[84:87], v[242:245]
    v_mfma_f32_16x16x32_bf16 v[246:249], v[96:99], v[84:87], v[246:249]
    v_mfma_f32_16x16x32_bf16 v[250:253], v[100:103], v[84:87], v[250:253]
    s_waitcnt lgkmcnt(0)
    v_mfma_f32_16x16x32_bf16 v[170:173], v[56:59], v[32:35], v[170:173]
    ds_read_b128 v[92:95], v31 offset:0
    ds_read_b64_tr_b16 v[68:69], v17 offset:10240
    v_mfma_f32_16x16x32_bf16 v[174:177], v[60:63], v[32:35], v[174:177]
    ds_read_b64_tr_b16 v[70:71], v17 offset:11520
    ds_read_b128 v[96:99], v31 offset:2048
    v_mfma_f32_16x16x32_bf16 v[178:181], v[64:67], v[32:35], v[178:181]
    ds_read_b128 v[100:103], v31 offset:4096
    ds_read_b64_tr_b16 v[72:73], v19 offset:10272
    v_mfma_f32_16x16x32_bf16 v[188:191], v[56:59], v[36:39], v[188:191]
    ds_read_b64_tr_b16 v[74:75], v19 offset:11552
    v_mfma_f32_16x16x32_bf16 v[192:195], v[60:63], v[36:39], v[192:195]
    ds_read_b64_tr_b16 v[76:77], v17 offset:10304
    v_mfma_f32_16x16x32_bf16 v[196:199], v[64:67], v[36:39], v[196:199]
    ds_read_b64_tr_b16 v[78:79], v17 offset:11584
    v_mfma_f32_16x16x32_bf16 v[206:209], v[56:59], v[40:43], v[206:209]
    ds_read_b64_tr_b16 v[80:81], v19 offset:10336
    v_mfma_f32_16x16x32_bf16 v[210:213], v[60:63], v[40:43], v[210:213]
    ds_read_b64_tr_b16 v[82:83], v19 offset:11616
    v_mfma_f32_16x16x32_bf16 v[214:217], v[64:67], v[40:43], v[214:217]
    ds_read_b64_tr_b16 v[84:85], v17 offset:10368
    v_mfma_f32_16x16x32_bf16 v[224:227], v[56:59], v[44:47], v[224:227]
    ds_read_b64_tr_b16 v[86:87], v17 offset:11648
    v_mfma_f32_16x16x32_bf16 v[228:231], v[60:63], v[44:47], v[228:231]
    ds_read_b32 v15, v14 offset:384
    v_mfma_f32_16x16x32_bf16 v[232:235], v[64:67], v[44:47], v[232:235]
    v_mfma_f32_16x16x32_bf16 v[242:245], v[56:59], v[48:51], v[242:245]
    v_mfma_f32_16x16x32_bf16 v[246:249], v[60:63], v[48:51], v[246:249]
    v_mfma_f32_16x16x32_bf16 v[250:253], v[64:67], v[48:51], v[250:253]
    s_waitcnt lgkmcnt(0)
    v_cmp_ne_u32 vcc, 0, v15
    v_mfma_f32_16x16x32_bf16 v[170:173], v[92:95], v[68:71], v[170:173]
    s_barrier
    s_cbranch_vccnz L_slow24
L_cont24:
    v_mfma_f32_16x16x32_bf16 v[174:177], v[96:99], v[68:71], v[174:177]
    ds_read_b128 v[56:59], v22 offset:40960
    ds_read_b64_tr_b16 v[32:33], v16 offset:40960
    v_mfma_f32_16x16x32_bf16 v[178:181], v[100:103], v[68:71], v[178:181]
    ds_read_b64_tr_b16 v[34:35], v16 offset:42240
    ds_read_b128 v[60:63], v22 offset:43008
    v_mfma_f32_16x16x32_bf16 v[188:191], v[92:95], v[72:75], v[188:191]
    ds_read_b128 v[64:67], v22 offset:45056
    ds_read_b64_tr_b16 v[36:37], v18 offset:40992
    v_mfma_f32_16x16x32_bf16 v[192:195], v[96:99], v[72:75], v[192:195]
    ds_read_b64_tr_b16 v[38:39], v18 offset:42272
    v_mfma_f32_16x16x32_bf16 v[196:199], v[100:103], v[72:75], v[196:199]
    ds_read_b64_tr_b16 v[40:41], v16 offset:41024
    v_mfma_f32_16x16x32_bf16 v[206:209], v[92:95], v[76:79], v[206:209]
    ds_read_b64_tr_b16 v[42:43], v16 offset:42304
    v_mfma_f32_16x16x32_bf16 v[210:213], v[96:99], v[76:79], v[210:213]
    ds_read_b64_tr_b16 v[44:45], v18 offset:41056
    v_mfma_f32_16x16x32_bf16 v[214:217], v[100:103], v[76:79], v[214:217]
    ds_read_b64_tr_b16 v[46:47], v18 offset:42336
    v_mfma_f32_16x16x32_bf16 v[224:227], v[92:95], v[80:83], v[224:227]
    ds_read_b64_tr_b16 v[48:49], v16 offset:41088
    v_mfma_f32_16x16x32_bf16 v[228:231], v[96:99], v[80:83], v[228:231]
    ds_read_b64_tr_b16 v[50:51], v16 offset:42368
    v_mfma_f32_16x16x32_bf16 v[232:235], v[100:103], v[80:83], v[232:235]
    v_mfma_f32_16x16x32_bf16 v[242:245], v[92:95], v[84:87], v[242:245]
    v_mfma_f32_16x16x32_bf16 v[246:249], v[96:99], v[84:87], v[246:249]
    v_mfma_f32_16x16x32_bf16 v[250:253], v[100:103], v[84:87], v[250:253]
    s_waitcnt lgkmcnt(0)
    v_mfma_f32_16x16x32_bf16 v[170:173], v[56:59], v[32:35], v[170:173]
    ds_read_b128 v[92:95], v23 offset:40960
    ds_read_b64_tr_b16 v[68:69], v16 offset:51200
    v_mfma_f32_16x16x32_bf16 v[174:177], v[60:63], v[32:35], v[174:177]
    ds_read_b64_tr_b16 v[70:71], v16 offset:52480
    ds_read_b128 v[96:99], v23 offset:43008
    v_mfma_f32_16x16x32_bf16 v[178:181], v[64:67], v[32:35], v[178:181]
    ds_read_b128 v[100:103], v23 offset:45056
    ds_read_b64_tr_b16 v[72:73], v18 offset:51232
    v_mfma_f32_16x16x32_bf16 v[188:191], v[56:59], v[36:39], v[188:191]
    ds_read_b64_tr_b16 v[74:75], v18 offset:52512
    v_mfma_f32_16x16x32_bf16 v[192:195], v[60:63], v[36:39], v[192:195]
    ds_read_b64_tr_b16 v[76:77], v16 offset:51264
    v_mfma_f32_16x16x32_bf16 v[196:199], v[64:67], v[36:39], v[196:199]
    ds_read_b64_tr_b16 v[78:79], v16 offset:52544
    v_mfma_f32_16x16x32_bf16 v[206:209], v[56:59], v[40:43], v[206:209]
    ds_read_b64_tr_b16 v[80:81], v18 offset:51296
    v_mfma_f32_16x16x32_bf16 v[210:213], v[60:63], v[40:43], v[210:213]
    ds_read_b64_tr_b16 v[82:83], v18 offset:52576
    v_mfma_f32_16x16x32_bf16 v[214:217], v[64:67], v[40:43], v[214:217]
    ds_read_b64_tr_b16 v[84:85], v16 offset:51328
    v_mfma_f32_16x16x32_bf16 v[224:227], v[56:59], v[44:47], v[224:227]
    ds_read_b64_tr_b16 v[86:87], v16 offset:52608
    v_mfma_f32_16x16x32_bf16 v[228:231], v[60:63], v[44:47], v[228:231]
    ds_read_b32 v15, v14 offset:400
    v_mfma_f32_16x16x32_bf16 v[232:235], v[64:67], v[44:47], v[232:235]
    v_mfma_f32_16x16x32_bf16 v[242:245], v[56:59], v[48:51], v[242:245]
    v_mfma_f32_16x16x32_bf16 v[246:249], v[60:63], v[48:51], v[246:249]
    v_mfma_f32_16x16x32_bf16 v[250:253], v[64:67], v[48:51], v[250:253]
    s_waitcnt lgkmcnt(0)
    v_cmp_ne_u32 vcc, 0, v15
    v_mfma_f32_16x16x32_bf16 v[170:173], v[92:95], v[68:71], v[170:173]
    s_barrier
    s_cbranch_vccnz L_slow25
L_cont25:
    v_mfma_f32_16x16x32_bf16 v[174:177], v[96:99], v[68:71], v[174:177]
    ds_read_b128 v[56:59], v22 offset:0
    ds_read_b64_tr_b16 v[32:33], v16 offset:0
    v_mfma_f32_16x16x32_bf16 v[178:181], v[100:103], v[68:71], v[178:181]
    ds_read_b64_tr_b16 v[34:35], v16 offset:1280
    ds_read_b128 v[60:63], v22 offset:2048
    v_mfma_f32_16x16x32_bf16 v[188:191], v[92:95], v[72:75], v[188:191]
    ds_read_b128 v[64:67], v22 offset:4096
    ds_read_b64_tr_b16 v[36:37], v18 offset:32
    v_mfma_f32_16x16x32_bf16 v[192:195], v[96:99], v[72:75], v[192:195]
    ds_read_b64_tr_b16 v[38:39], v18 offset:1312
    v_mfma_f32_16x16x32_bf16 v[196:199], v[100:103], v[72:75], v[196:199]
    ds_read_b64_tr_b16 v[40:41], v16 offset:64
    v_mfma_f32_16x16x32_bf16 v[206:209], v[92:95], v[76:79], v[206:209]
    ds_read_b64_tr_b16 v[42:43], v16 offset:1344
    v_cvt_pk_bf16_f32 v164, v170, v171
    v_cvt_pk_bf16_f32 v165, v172, v173
    v_mfma_f32_16x16x32_bf16 v[210:213], v[96:99], v[76:79], v[210:213]
    ds_read_b64_tr_b16 v[44:45], v18 offset:96
    v_cvt_pk_bf16_f32 v166, v174, v175
    v_cvt_pk_bf16_f32 v167, v176, v177
    v_mfma_f32_16x16x32_bf16 v[214:217], v[100:103], v[76:79], v[214:217]
    ds_read_b64_tr_b16 v[46:47], v18 offset:1376
    v_cvt_pk_bf16_f32 v168, v178, v179
    v_cvt_pk_bf16_f32 v169, v180, v181
    v_mfma_f32_16x16x32_bf16 v[224:227], v[92:95], v[80:83], v[224:227]
    ds_read_b64_tr_b16 v[48:49], v16 offset:128
    v_cvt_pk_bf16_f32 v182, v188, v189
    v_cvt_pk_bf16_f32 v183, v190, v191
    v_mfma_f32_16x16x32_bf16 v[228:231], v[96:99], v[80:83], v[228:231]
    ds_read_b64_tr_b16 v[50:51], v16 offset:1408
    v_cvt_pk_bf16_f32 v184, v192, v193
    v_cvt_pk_bf16_f32 v185, v194, v195
    v_mfma_f32_16x16x32_bf16 v[232:235], v[100:103], v[80:83], v[232:235]
    v_cvt_pk_bf16_f32 v186, v196, v197
    v_cvt_pk_bf16_f32 v187, v198, v199
    v_mfma_f32_16x16x32_bf16 v[242:245], v[92:95], v[84:87], v[242:245]
    v_cvt_pk_bf16_f32 v200, v206, v207
    v_cvt_pk_bf16_f32 v201, v208, v209
    v_mfma_f32_16x16x32_bf16 v[246:249], v[96:99], v[84:87], v[246:249]
    v_cvt_pk_bf16_f32 v202, v210, v211
    v_cvt_pk_bf16_f32 v203, v212, v213
    v_mfma_f32_16x16x32_bf16 v[250:253], v[100:103], v[84:87], v[250:253]
    v_cvt_pk_bf16_f32 v204, v214, v215
    v_cvt_pk_bf16_f32 v205, v216, v217
    s_waitcnt lgkmcnt(0)
    v_mfma_f32_16x16x32_bf16 v[170:173], v[56:59], v[32:35], 0
    ds_read_b128 v[92:95], v23 offset:0
    ds_read_b64_tr_b16 v[68:69], v16 offset:10240
    v_cvt_pk_bf16_f32 v218, v224, v225
    v_cvt_pk_bf16_f32 v219, v226, v227
    v_mfma_f32_16x16x32_bf16 v[174:177], v[60:63], v[32:35], 0
    ds_read_b64_tr_b16 v[70:71], v16 offset:11520
    ds_read_b128 v[96:99], v23 offset:2048
    v_cvt_pk_bf16_f32 v220, v228, v229
    v_cvt_pk_bf16_f32 v221, v230, v231
    v_mfma_f32_16x16x32_bf16 v[178:181], v[64:67], v[32:35], 0
    ds_read_b128 v[100:103], v23 offset:4096
    ds_read_b64_tr_b16 v[72:73], v18 offset:10272
    v_cvt_pk_bf16_f32 v222, v232, v233
    v_cvt_pk_bf16_f32 v223, v234, v235
    v_mfma_f32_16x16x32_bf16 v[188:191], v[56:59], v[36:39], 0
    ds_read_b64_tr_b16 v[74:75], v18 offset:11552
    v_cvt_pk_bf16_f32 v236, v242, v243
    v_cvt_pk_bf16_f32 v237, v244, v245
    v_mfma_f32_16x16x32_bf16 v[192:195], v[60:63], v[36:39], 0
    ds_read_b64_tr_b16 v[76:77], v16 offset:10304
    v_cvt_pk_bf16_f32 v238, v246, v247
    v_cvt_pk_bf16_f32 v239, v248, v249
    v_mfma_f32_16x16x32_bf16 v[196:199], v[64:67], v[36:39], 0
    ds_read_b64_tr_b16 v[78:79], v16 offset:11584
    v_cvt_pk_bf16_f32 v240, v250, v251
    v_cvt_pk_bf16_f32 v241, v252, v253
    v_mfma_f32_16x16x32_bf16 v[206:209], v[56:59], v[40:43], 0
    ds_read_b64_tr_b16 v[80:81], v18 offset:10336
    v_mfma_f32_16x16x32_bf16 v[210:213], v[60:63], v[40:43], 0
    ds_read_b64_tr_b16 v[82:83], v18 offset:11616
    v_mfma_f32_16x16x32_bf16 v[214:217], v[64:67], v[40:43], 0
    ds_read_b64_tr_b16 v[84:85], v16 offset:10368
    v_mfma_f32_16x16x32_bf16 v[224:227], v[56:59], v[44:47], 0
    ds_read_b64_tr_b16 v[86:87], v16 offset:11648
    v_mfma_f32_16x16x32_bf16 v[228:231], v[60:63], v[44:47], 0
    ds_read_b32 v15, v14 offset:416
    v_mfma_f32_16x16x32_bf16 v[232:235], v[64:67], v[44:47], 0
    v_mfma_f32_16x16x32_bf16 v[242:245], v[56:59], v[48:51], 0
    v_mfma_f32_16x16x32_bf16 v[246:249], v[60:63], v[48:51], 0
    v_mfma_f32_16x16x32_bf16 v[250:253], v[64:67], v[48:51], 0
    s_waitcnt lgkmcnt(0)
    v_cmp_ne_u32 vcc, 0, v15
    v_mfma_f32_16x16x32_bf16 v[170:173], v[92:95], v[68:71], v[170:173]
    s_cbranch_vccnz L_slow26
L_cont26:
    v_mfma_f32_16x16x32_bf16 v[174:177], v[96:99], v[68:71], v[174:177]
    ds_read_b128 v[56:59], v30 offset:40960
    ds_read_b64_tr_b16 v[32:33], v17 offset:40960
    v_mfma_f32_16x16x32_bf16 v[178:181], v[100:103], v[68:71], v[178:181]
    ds_read_b64_tr_b16 v[34:35], v17 offset:42240
    ds_read_b128 v[60:63], v30 offset:43008
    v_mfma_f32_16x16x32_bf16 v[188:191], v[92:95], v[72:75], v[188:191]
    ds_read_b128 v[64:67], v30 offset:45056
    ds_read_b64_tr_b16 v[36:37], v19 offset:40992
    v_mfma_f32_16x16x32_bf16 v[192:195], v[96:99], v[72:75], v[192:195]
    ds_read_b64_tr_b16 v[38:39], v19 offset:42272
    v_mfma_f32_16x16x32_bf16 v[196:199], v[100:103], v[72:75], v[196:199]
    ds_read_b64_tr_b16 v[40:41], v17 offset:41024
    v_mfma_f32_16x16x32_bf16 v[206:209], v[92:95], v[76:79], v[206:209]
    ds_read_b64_tr_b16 v[42:43], v17 offset:42304
    v_mfma_f32_16x16x32_bf16 v[210:213], v[96:99], v[76:79], v[210:213]
    ds_read_b64_tr_b16 v[44:45], v19 offset:41056
    v_mfma_f32_16x16x32_bf16 v[214:217], v[100:103], v[76:79], v[214:217]
    ds_read_b64_tr_b16 v[46:47], v19 offset:42336
    v_mfma_f32_16x16x32_bf16 v[224:227], v[92:95], v[80:83], v[224:227]
    ds_read_b64_tr_b16 v[48:49], v17 offset:41088
    v_mfma_f32_16x16x32_bf16 v[228:231], v[96:99], v[80:83], v[228:231]
    ds_read_b64_tr_b16 v[50:51], v17 offset:42368
    v_mfma_f32_16x16x32_bf16 v[232:235], v[100:103], v[80:83], v[232:235]
    v_mfma_f32_16x16x32_bf16 v[242:245], v[92:95], v[84:87], v[242:245]
    v_mfma_f32_16x16x32_bf16 v[246:249], v[96:99], v[84:87], v[246:249]
    v_mfma_f32_16x16x32_bf16 v[250:253], v[100:103], v[84:87], v[250:253]
    s_waitcnt lgkmcnt(0)
    v_mfma_f32_16x16x32_bf16 v[170:173], v[56:59], v[32:35], v[170:173]
    ds_read_b128 v[92:95], v31 offset:40960
    ds_read_b64_tr_b16 v[68:69], v17 offset:51200
    v_mfma_f32_16x16x32_bf16 v[174:177], v[60:63], v[32:35], v[174:177]
    ds_read_b64_tr_b16 v[70:71], v17 offset:52480
    ds_read_b128 v[96:99], v31 offset:43008
    v_mfma_f32_16x16x32_bf16 v[178:181], v[64:67], v[32:35], v[178:181]
    ds_read_b128 v[100:103], v31 offset:45056
    ds_read_b64_tr_b16 v[72:73], v19 offset:51232
    v_mfma_f32_16x16x32_bf16 v[188:191], v[56:59], v[36:39], v[188:191]
    ds_read_b64_tr_b16 v[74:75], v19 offset:52512
    v_mfma_f32_16x16x32_bf16 v[192:195], v[60:63], v[36:39], v[192:195]
    ds_read_b64_tr_b16 v[76:77], v17 offset:51264
    v_mfma_f32_16x16x32_bf16 v[196:199], v[64:67], v[36:39], v[196:199]
    ds_read_b64_tr_b16 v[78:79], v17 offset:52544
    v_mfma_f32_16x16x32_bf16 v[206:209], v[56:59], v[40:43], v[206:209]
    ds_read_b64_tr_b16 v[80:81], v19 offset:51296
    v_mfma_f32_16x16x32_bf16 v[210:213], v[60:63], v[40:43], v[210:213]
    ds_read_b64_tr_b16 v[82:83], v19 offset:52576
    v_mfma_f32_16x16x32_bf16 v[214:217], v[64:67], v[40:43], v[214:217]
    ds_read_b64_tr_b16 v[84:85], v17 offset:51328
    v_mfma_f32_16x16x32_bf16 v[224:227], v[56:59], v[44:47], v[224:227]
    ds_read_b64_tr_b16 v[86:87], v17 offset:52608
    v_mfma_f32_16x16x32_bf16 v[228:231], v[60:63], v[44:47], v[228:231]
    ds_read_b32 v15, v14 offset:432
    v_mfma_f32_16x16x32_bf16 v[232:235], v[64:67], v[44:47], v[232:235]
    v_mfma_f32_16x16x32_bf16 v[242:245], v[56:59], v[48:51], v[242:245]
    v_mfma_f32_16x16x32_bf16 v[246:249], v[60:63], v[48:51], v[246:249]
    v_mfma_f32_16x16x32_bf16 v[250:253], v[64:67], v[48:51], v[250:253]
    s_waitcnt lgkmcnt(0)
    v_cmp_ne_u32 vcc, 0, v15
    v_mfma_f32_16x16x32_bf16 v[170:173], v[92:95], v[68:71], v[170:173]
    s_cbranch_vccnz L_slow27
L_cont27:
    v_mfma_f32_16x16x32_bf16 v[174:177], v[96:99], v[68:71], v[174:177]
    ds_read_b128 v[56:59], v30 offset:0
    ds_read_b64_tr_b16 v[32:33], v17 offset:0
    v_mfma_f32_16x16x32_bf16 v[178:181], v[100:103], v[68:71], v[178:181]
    ds_read_b64_tr_b16 v[34:35], v17 offset:1280
    ds_read_b128 v[60:63], v30 offset:2048
    v_mfma_f32_16x16x32_bf16 v[188:191], v[92:95], v[72:75], v[188:191]
    ds_read_b128 v[64:67], v30 offset:4096
    ds_read_b64_tr_b16 v[36:37], v19 offset:32
    v_mfma_f32_16x16x32_bf16 v[192:195], v[96:99], v[72:75], v[192:195]
    ds_read_b64_tr_b16 v[38:39], v19 offset:1312
    v_mfma_f32_16x16x32_bf16 v[196:199], v[100:103], v[72:75], v[196:199]
    ds_read_b64_tr_b16 v[40:41], v17 offset:64
    v_mfma_f32_16x16x32_bf16 v[206:209], v[92:95], v[76:79], v[206:209]
    ds_read_b64_tr_b16 v[42:43], v17 offset:1344
    v_mfma_f32_16x16x32_bf16 v[210:213], v[96:99], v[76:79], v[210:213]
    ds_read_b64_tr_b16 v[44:45], v19 offset:96
    v_mfma_f32_16x16x32_bf16 v[214:217], v[100:103], v[76:79], v[214:217]
    ds_read_b64_tr_b16 v[46:47], v19 offset:1376
    v_mfma_f32_16x16x32_bf16 v[224:227], v[92:95], v[80:83], v[224:227]
    ds_read_b64_tr_b16 v[48:49], v17 offset:128
    v_mfma_f32_16x16x32_bf16 v[228:231], v[96:99], v[80:83], v[228:231]
    ds_read_b64_tr_b16 v[50:51], v17 offset:1408
    v_mfma_f32_16x16x32_bf16 v[232:235], v[100:103], v[80:83], v[232:235]
    v_mfma_f32_16x16x32_bf16 v[242:245], v[92:95], v[84:87], v[242:245]
    v_mfma_f32_16x16x32_bf16 v[246:249], v[96:99], v[84:87], v[246:249]
    v_mfma_f32_16x16x32_bf16 v[250:253], v[100:103], v[84:87], v[250:253]
    s_waitcnt lgkmcnt(0)
    v_mfma_f32_16x16x32_bf16 v[170:173], v[56:59], v[32:35], v[170:173]
    ds_read_b128 v[92:95], v31 offset:0
    ds_read_b64_tr_b16 v[68:69], v17 offset:10240
    v_mfma_f32_16x16x32_bf16 v[174:177], v[60:63], v[32:35], v[174:177]
    ds_read_b64_tr_b16 v[70:71], v17 offset:11520
    ds_read_b128 v[96:99], v31 offset:2048
    v_mfma_f32_16x16x32_bf16 v[178:181], v[64:67], v[32:35], v[178:181]
    ds_read_b128 v[100:103], v31 offset:4096
    ds_read_b64_tr_b16 v[72:73], v19 offset:10272
    v_mfma_f32_16x16x32_bf16 v[188:191], v[56:59], v[36:39], v[188:191]
    ds_read_b64_tr_b16 v[74:75], v19 offset:11552
    v_mfma_f32_16x16x32_bf16 v[192:195], v[60:63], v[36:39], v[192:195]
    ds_read_b64_tr_b16 v[76:77], v17 offset:10304
    v_mfma_f32_16x16x32_bf16 v[196:199], v[64:67], v[36:39], v[196:199]
    ds_read_b64_tr_b16 v[78:79], v17 offset:11584
    v_mfma_f32_16x16x32_bf16 v[206:209], v[56:59], v[40:43], v[206:209]
    ds_read_b64_tr_b16 v[80:81], v19 offset:10336
    v_mfma_f32_16x16x32_bf16 v[210:213], v[60:63], v[40:43], v[210:213]
    ds_read_b64_tr_b16 v[82:83], v19 offset:11616
    v_mfma_f32_16x16x32_bf16 v[214:217], v[64:67], v[40:43], v[214:217]
    ds_read_b64_tr_b16 v[84:85], v17 offset:10368
    v_mfma_f32_16x16x32_bf16 v[224:227], v[56:59], v[44:47], v[224:227]
    ds_read_b64_tr_b16 v[86:87], v17 offset:11648
    v_mfma_f32_16x16x32_bf16 v[228:231], v[60:63], v[44:47], v[228:231]
    ds_read_b32 v15, v14 offset:480
    v_mfma_f32_16x16x32_bf16 v[232:235], v[64:67], v[44:47], v[232:235]
    v_mfma_f32_16x16x32_bf16 v[242:245], v[56:59], v[48:51], v[242:245]
    v_mfma_f32_16x16x32_bf16 v[246:249], v[60:63], v[48:51], v[246:249]
    v_mfma_f32_16x16x32_bf16 v[250:253], v[64:67], v[48:51], v[250:253]
    s_waitcnt lgkmcnt(0)
    v_cmp_ne_u32 vcc, 0, v15
    v_mfma_f32_16x16x32_bf16 v[170:173], v[92:95], v[68:71], v[170:173]
    s_cbranch_vccnz L_slow30
L_cont30:
    v_mfma_f32_16x16x32_bf16 v[174:177], v[96:99], v[68:71], v[174:177]
    ds_read_b128 v[32:35], v24 offset:0
    ds_read_b64 v[36:37], v25 offset:2560
    v_mfma_f32_16x16x32_bf16 v[178:181], v[100:103], v[68:71], v[178:181]
    ds_read_b64 v[38:39], v24 offset:4608
    ds_read_b64 v[40:41], v24 offset:4616
    v_mfma_f32_16x16x32_bf16 v[188:191], v[92:95], v[72:75], v[188:191]
    ds_read_b64 v[42:43], v25 offset:7168
    ds_read_b128 v[44:47], v24 offset:9216
    v_mfma_f32_16x16x32_bf16 v[192:195], v[96:99], v[72:75], v[192:195]
    ds_read_b64 v[48:49], v25 offset:11776
    v_mfma_f32_16x16x32_bf16 v[196:199], v[100:103], v[72:75], v[196:199]
    ds_read_b64 v[50:51], v24 offset:13824
    v_mfma_f32_16x16x32_bf16 v[206:209], v[92:95], v[76:79], v[206:209]
    ds_read_b64 v[52:53], v24 offset:13832
    v_cvt_pk_bf16_f32 v170, v170, v171
    v_cvt_pk_bf16_f32 v171, v172, v173
    v_mfma_f32_16x16x32_bf16 v[210:213], v[96:99], v[76:79], v[210:213]
    ds_read_b64 v[54:55], v25 offset:16384
    v_cvt_pk_bf16_f32 v172, v174, v175
    v_cvt_pk_bf16_f32 v173, v176, v177
    v_mfma_f32_16x16x32_bf16 v[214:217], v[100:103], v[76:79], v[214:217]
    v_cvt_pk_bf16_f32 v174, v178, v179
    v_cvt_pk_bf16_f32 v175, v180, v181
    v_mfma_f32_16x16x32_bf16 v[224:227], v[92:95], v[80:83], v[224:227]
    v_cvt_pk_bf16_f32 v188, v188, v189
    v_cvt_pk_bf16_f32 v189, v190, v191
    v_mfma_f32_16x16x32_bf16 v[228:231], v[96:99], v[80:83], v[228:231]
    v_cvt_pk_bf16_f32 v190, v192, v193
    v_cvt_pk_bf16_f32 v191, v194, v195
    v_mfma_f32_16x16x32_bf16 v[232:235], v[100:103], v[80:83], v[232:235]
    v_cvt_pk_bf16_f32 v192, v196, v197
    v_cvt_pk_bf16_f32 v193, v198, v199
    v_mfma_f32_16x16x32_bf16 v[242:245], v[92:95], v[84:87], v[242:245]
    v_cvt_pk_bf16_f32 v206, v206, v207
    v_cvt_pk_bf16_f32 v207, v208, v209
    v_mfma_f32_16x16x32_bf16 v[246:249], v[96:99], v[84:87], v[246:249]
    v_cvt_pk_bf16_f32 v208, v210, v211
    v_cvt_pk_bf16_f32 v209, v212, v213
    v_mfma_f32_16x16x32_bf16 v[250:253], v[100:103], v[84:87], v[250:253]
    v_cvt_pk_bf16_f32 v210, v214, v215
    v_cvt_pk_bf16_f32 v211, v216, v217
    s_lshl_b32 s53, s3, 2
    s_add_u32 s53, s53, s52
    s_lshl_b32 s68, s53, 10
    s_add_u32 s68, s68, 3407872
    s_lshl_b32 s67, s53, 16
    s_add_u32 s67, s67, 4194304
    s_lshl_b32 s54, s48, 10
    s_add_u32 s54, s54, s67
    s_waitcnt lgkmcnt(0)
    v_mfma_f32_16x16x32_bf16 v[68:71], v[104:107], v[32:35], 0
    ds_read_b128 v[56:59], v24 offset:1024
    ds_read_b64 v[60:61], v25 offset:3072
    v_cvt_pk_bf16_f32 v224, v224, v225
    v_cvt_pk_bf16_f32 v225, v226, v227
    v_cvt_pk_bf16_f32 v226, v228, v229
    v_mfma_f32_16x16x32_bf16 v[72:75], v[116:119], v[32:35], 0
    ds_read_b64 v[62:63], v24 offset:5632
    ds_read_b64 v[64:65], v24 offset:5640
    v_cvt_pk_bf16_f32 v227, v230, v231
    v_cvt_pk_bf16_f32 v228, v232, v233
    v_cvt_pk_bf16_f32 v229, v234, v235
    v_mfma_f32_16x16x32_bf16 v[76:79], v[128:131], v[32:35], 0
    ds_read_b64 v[66:67], v25 offset:7680
    v_cvt_pk_bf16_f32 v242, v242, v243
    v_cvt_pk_bf16_f32 v243, v244, v245
    v_cvt_pk_bf16_f32 v244, v246, v247
    v_mfma_f32_16x16x32_bf16 v[80:83], v[140:143], v[32:35], 0
    v_cvt_pk_bf16_f32 v245, v248, v249
    v_cvt_pk_bf16_f32 v246, v250, v251
    v_cvt_pk_bf16_f32 v247, v252, v253
    v_mfma_f32_16x16x32_bf16 v[84:87], v[152:155], v[32:35], 0
    v_mfma_f32_16x16x32_bf16 v[68:71], v[108:111], v[36:39], v[68:71]
    v_mfma_f32_16x16x32_bf16 v[72:75], v[120:123], v[36:39], v[72:75]
    v_mfma_f32_16x16x32_bf16 v[76:79], v[132:135], v[36:39], v[76:79]
    v_mfma_f32_16x16x32_bf16 v[80:83], v[144:147], v[36:39], v[80:83]
    v_mfma_f32_16x16x32_bf16 v[84:87], v[156:159], v[36:39], v[84:87]
    v_mfma_f32_16x16x32_bf16 v[68:71], v[112:115], v[40:43], v[68:71]
    v_mfma_f32_16x16x32_bf16 v[72:75], v[124:127], v[40:43], v[72:75]
    v_mfma_f32_16x16x32_bf16 v[76:79], v[136:139], v[40:43], v[76:79]
    v_mfma_f32_16x16x32_bf16 v[80:83], v[148:151], v[40:43], v[80:83]
    v_mfma_f32_16x16x32_bf16 v[84:87], v[160:163], v[40:43], v[84:87]
    s_waitcnt lgkmcnt(0)
    v_mfma_f32_16x16x32_bf16 v[68:71], v[164:167], v[44:47], v[68:71]
    ds_read_b128 v[32:35], v24 offset:10240
    ds_read_b64 v[36:37], v25 offset:12288
    v_mfma_f32_16x16x32_bf16 v[72:75], v[182:185], v[44:47], v[72:75]
    ds_read_b64 v[38:39], v24 offset:14848
    ds_read_b64 v[40:41], v24 offset:14856
    v_mfma_f32_16x16x32_bf16 v[76:79], v[200:203], v[44:47], v[76:79]
    ds_read_b64 v[42:43], v25 offset:16896
    v_mfma_f32_16x16x32_bf16 v[80:83], v[218:221], v[44:47], v[80:83]
    v_mfma_f32_16x16x32_bf16 v[84:87], v[236:239], v[44:47], v[84:87]
    v_mfma_f32_16x16x32_bf16 v[68:71], v[168:171], v[48:51], v[68:71]
    v_mfma_f32_16x16x32_bf16 v[72:75], v[186:189], v[48:51], v[72:75]
    v_mfma_f32_16x16x32_bf16 v[76:79], v[204:207], v[48:51], v[76:79]
    v_mfma_f32_16x16x32_bf16 v[80:83], v[222:225], v[48:51], v[80:83]
    v_mfma_f32_16x16x32_bf16 v[84:87], v[240:243], v[48:51], v[84:87]
    v_mfma_f32_16x16x32_bf16 v[68:71], v[172:175], v[52:55], v[68:71]
    v_mfma_f32_16x16x32_bf16 v[72:75], v[190:193], v[52:55], v[72:75]
    v_mfma_f32_16x16x32_bf16 v[76:79], v[208:211], v[52:55], v[76:79]
    v_mfma_f32_16x16x32_bf16 v[80:83], v[226:229], v[52:55], v[80:83]
    v_mfma_f32_16x16x32_bf16 v[84:87], v[244:247], v[52:55], v[84:87]
    s_waitcnt lgkmcnt(0)
    v_mfma_f32_16x16x32_bf16 v[88:91], v[104:107], v[56:59], 0
    ds_read_b128 v[44:47], v24 offset:2048
    ds_read_b64 v[48:49], v25 offset:3584
    v_mfma_f32_16x16x32_bf16 v[92:95], v[116:119], v[56:59], 0
    ds_read_b64 v[50:51], v24 offset:6656
    ds_read_b64 v[52:53], v24 offset:6664
    v_mfma_f32_16x16x32_bf16 v[96:99], v[128:131], v[56:59], 0
    ds_read_b64 v[54:55], v25 offset:8192
    v_mfma_f32_16x16x32_bf16 v[100:103], v[140:143], v[56:59], 0
    v_mfma_f32_16x16x32_bf16 v[176:179], v[152:155], v[56:59], 0
    v_mfma_f32_16x16x32_bf16 v[88:91], v[108:111], v[60:63], v[88:91]
    v_mfma_f32_16x16x32_bf16 v[92:95], v[120:123], v[60:63], v[92:95]
    v_mfma_f32_16x16x32_bf16 v[96:99], v[132:135], v[60:63], v[96:99]
    v_mfma_f32_16x16x32_bf16 v[100:103], v[144:147], v[60:63], v[100:103]
    v_mfma_f32_16x16x32_bf16 v[176:179], v[156:159], v[60:63], v[176:179]
    s_cmp_eq_u32 s48, 0
    s_cbranch_scc1 L_own0
    v_cvt_pk_bf16_f32 v68, v68, v69
    v_cvt_pk_bf16_f32 v69, v70, v71
    v_cvt_pk_bf16_f32 v70, v72, v73
    v_cvt_pk_bf16_f32 v71, v74, v75
    s_add_u32 s63, s54, 0
    buffer_store_dwordx4 v[68:71], v10, s[44:47], s63 offen sc1
    L_ownr0:
    v_mfma_f32_16x16x32_bf16 v[88:91], v[112:115], v[64:67], v[88:91]
    v_mfma_f32_16x16x32_bf16 v[92:95], v[124:127], v[64:67], v[92:95]
    v_mfma_f32_16x16x32_bf16 v[96:99], v[136:139], v[64:67], v[96:99]
    v_mfma_f32_16x16x32_bf16 v[100:103], v[148:151], v[64:67], v[100:103]
    v_mfma_f32_16x16x32_bf16 v[176:179], v[160:163], v[64:67], v[176:179]
    s_cmp_eq_u32 s48, 1
    s_cbranch_scc1 L_own1
    v_cvt_pk_bf16_f32 v76, v76, v77
    v_cvt_pk_bf16_f32 v77, v78, v79
    v_cvt_pk_bf16_f32 v78, v80, v81
    v_cvt_pk_bf16_f32 v79, v82, v83
    s_add_u32 s63, s54, 8192
    buffer_store_dwordx4 v[76:79], v10, s[44:47], s63 offen sc1
    L_ownr1:
    s_waitcnt lgkmcnt(0)
    v_mfma_f32_16x16x32_bf16 v[88:91], v[164:167], v[32:35], v[88:91]
    ds_read_b128 v[56:59], v24 offset:11264
    ds_read_b64 v[60:61], v25 offset:12800
    v_mfma_f32_16x16x32_bf16 v[92:95], v[182:185], v[32:35], v[92:95]
    ds_read_b64 v[62:63], v24 offset:15872
    ds_read_b64 v[64:65], v24 offset:15880
    v_mfma_f32_16x16x32_bf16 v[96:99], v[200:203], v[32:35], v[96:99]
    ds_read_b64 v[66:67], v25 offset:17408
    v_mfma_f32_16x16x32_bf16 v[100:103], v[218:221], v[32:35], v[100:103]
    v_mfma_f32_16x16x32_bf16 v[176:179], v[236:239], v[32:35], v[176:179]
    v_mfma_f32_16x16x32_bf16 v[88:91], v[168:171], v[36:39], v[88:91]
    v_mfma_f32_16x16x32_bf16 v[92:95], v[186:189], v[36:39], v[92:95]
    v_mfma_f32_16x16x32_bf16 v[96:99], v[204:207], v[36:39], v[96:99]
    v_mfma_f32_16x16x32_bf16 v[100:103], v[222:225], v[36:39], v[100:103]
    v_mfma_f32_16x16x32_bf16 v[176:179], v[240:243], v[36:39], v[176:179]
    v_mfma_f32_16x16x32_bf16 v[88:91], v[172:175], v[40:43], v[88:91]
    v_mfma_f32_16x16x32_bf16 v[92:95], v[190:193], v[40:43], v[92:95]
    v_mfma_f32_16x16x32_bf16 v[96:99], v[208:211], v[40:43], v[96:99]
    v_mfma_f32_16x16x32_bf16 v[100:103], v[226:229], v[40:43], v[100:103]
    v_mfma_f32_16x16x32_bf16 v[176:179], v[244:247], v[40:43], v[176:179]
    s_waitcnt lgkmcnt(0)
    v_mfma_f32_16x16x32_bf16 v[194:197], v[104:107], v[44:47], 0
    v_mfma_f32_16x16x32_bf16 v[212:215], v[116:119], v[44:47], 0
    v_mfma_f32_16x16x32_bf16 v[230:233], v[128:131], v[44:47], 0
    v_mfma_f32_16x16x32_bf16 v[248:251], v[140:143], v[44:47], 0
    v_mfma_f32_16x16x32_bf16 v[26:29], v[152:155], v[44:47], 0
    v_mfma_f32_16x16x32_bf16 v[194:197], v[108:111], v[48:51], v[194:197]
    v_mfma_f32_16x16x32_bf16 v[212:215], v[120:123], v[48:51], v[212:215]
    v_mfma_f32_16x16x32_bf16 v[230:233], v[132:135], v[48:51], v[230:233]
    v_mfma_f32_16x16x32_bf16 v[248:251], v[144:147], v[48:51], v[248:251]
    v_mfma_f32_16x16x32_bf16 v[26:29], v[156:159], v[48:51], v[26:29]
    s_cmp_eq_u32 s48, 2
    s_cbranch_scc1 L_own2
    v_cvt_pk_bf16_f32 v84, v84, v85
    v_cvt_pk_bf16_f32 v85, v86, v87
    v_cvt_pk_bf16_f32 v86, v88, v89
    v_cvt_pk_bf16_f32 v87, v90, v91
    s_add_u32 s63, s54, 16384
    buffer_store_dwordx4 v[84:87], v10, s[44:47], s63 offen sc1
    L_ownr2:
    v_mfma_f32_16x16x32_bf16 v[194:197], v[112:115], v[52:55], v[194:197]
    v_mfma_f32_16x16x32_bf16 v[212:215], v[124:127], v[52:55], v[212:215]
    v_mfma_f32_16x16x32_bf16 v[230:233], v[136:139], v[52:55], v[230:233]
    v_mfma_f32_16x16x32_bf16 v[248:251], v[148:151], v[52:55], v[248:251]
    v_mfma_f32_16x16x32_bf16 v[26:29], v[160:163], v[52:55], v[26:29]
    s_cmp_eq_u32 s48, 3
    s_cbranch_scc1 L_own3
    v_cvt_pk_bf16_f32 v92, v92, v93
    v_cvt_pk_bf16_f32 v93, v94, v95
    v_cvt_pk_bf16_f32 v94, v96, v97
    v_cvt_pk_bf16_f32 v95, v98, v99
    s_add_u32 s63, s54, 24576
    buffer_store_dwordx4 v[92:95], v10, s[44:47], s63 offen sc1
    L_ownr3:
    s_waitcnt lgkmcnt(0)
    v_mfma_f32_16x16x32_bf16 v[194:197], v[164:167], v[56:59], v[194:197]
    v_mfma_f32_16x16x32_bf16 v[212:215], v[182:185], v[56:59], v[212:215]
    v_mfma_f32_16x16x32_bf16 v[230:233], v[200:203], v[56:59], v[230:233]
    v_mfma_f32_16x16x32_bf16 v[248:251], v[218:221], v[56:59], v[248:251]
    v_mfma_f32_16x16x32_bf16 v[26:29], v[236:239], v[56:59], v[26:29]
    s_cmp_eq_u32 s48, 4
    s_cbranch_scc1 L_own4
    v_cvt_pk_bf16_f32 v100, v100, v101
    v_cvt_pk_bf16_f32 v101, v102, v103
    v_cvt_pk_bf16_f32 v102, v176, v177
    v_cvt_pk_bf16_f32 v103, v178, v179
    s_add_u32 s63, s54, 32768
    buffer_store_dwordx4 v[100:103], v10, s[44:47], s63 offen sc1
    L_ownr4:
    v_mfma_f32_16x16x32_bf16 v[194:197], v[168:171], v[60:63], v[194:197]
    v_mfma_f32_16x16x32_bf16 v[212:215], v[186:189], v[60:63], v[212:215]
    v_mfma_f32_16x16x32_bf16 v[230:233], v[204:207], v[60:63], v[230:233]
    v_mfma_f32_16x16x32_bf16 v[248:251], v[222:225], v[60:63], v[248:251]
    v_mfma_f32_16x16x32_bf16 v[26:29], v[240:243], v[60:63], v[26:29]
    v_mfma_f32_16x16x32_bf16 v[194:197], v[172:175], v[64:67], v[194:197]
    v_mfma_f32_16x16x32_bf16 v[212:215], v[190:193], v[64:67], v[212:215]
    v_mfma_f32_16x16x32_bf16 v[230:233], v[208:211], v[64:67], v[230:233]
    v_mfma_f32_16x16x32_bf16 v[248:251], v[226:229], v[64:67], v[248:251]
    v_mfma_f32_16x16x32_bf16 v[26:29], v[244:247], v[64:67], v[26:29]
    s_cmp_eq_u32 s48, 5
    s_cbranch_scc1 L_own5
    s_nop 1
    v_cvt_pk_bf16_f32 v194, v194, v195
    v_cvt_pk_bf16_f32 v195, v196, v197
    v_cvt_pk_bf16_f32 v196, v212, v213
    v_cvt_pk_bf16_f32 v197, v214, v215
    s_add_u32 s63, s54, 40960
    buffer_store_dwordx4 v[194:197], v10, s[44:47], s63 offen sc1
    L_ownr5:
    s_cmp_eq_u32 s48, 6
    s_cbranch_scc1 L_own6
    v_cvt_pk_bf16_f32 v230, v230, v231
    v_cvt_pk_bf16_f32 v231, v232, v233
    v_cvt_pk_bf16_f32 v232, v248, v249
    v_cvt_pk_bf16_f32 v233, v250, v251
    s_add_u32 s63, s54, 49152
    buffer_store_dwordx4 v[230:233], v10, s[44:47], s63 offen sc1
    L_ownr6:
    s_cmp_eq_u32 s48, 7
    s_cbranch_scc1 L_own7
    v_cvt_pk_bf16_f32 v26, v26, v27
    v_cvt_pk_bf16_f32 v27, v28, v29
    s_add_u32 s63, s54, 57344
    buffer_store_dwordx4 v[26:29], v10, s[44:47], s63 offen sc1
    L_ownr7:
    s_lshl_b32 s54, s48, 2
    s_add_u32 s54, s54, s68
    v_lshlrev_b32 v22, 5, v11
    s_lshl_b32 s55, s48, 7
    s_add_u32 s68, s68, s55
    s_lshl_b32 s53, s48, 13
    s_add_u32 s53, s53, s67
    s_add_u32 s55, s48, 1
    s_and_b32 s55, s55, 7
    s_lshl_b32 s55, s55, 10
    s_add_u32 s4, s55, s53
    s_add_u32 s55, s48, 2
    s_and_b32 s55, s55, 7
    s_lshl_b32 s55, s55, 10
    s_add_u32 s5, s55, s53
    s_add_u32 s55, s48, 3
    s_and_b32 s55, s55, 7
    s_lshl_b32 s55, s55, 10
    s_add_u32 s6, s55, s53
    s_add_u32 s55, s48, 4
    s_and_b32 s55, s55, 7
    s_lshl_b32 s55, s55, 10
    s_add_u32 s7, s55, s53
    s_add_u32 s55, s48, 5
    s_and_b32 s55, s55, 7
    s_lshl_b32 s55, s55, 10
    s_add_u32 s8, s55, s53
    s_add_u32 s55, s48, 6
    s_and_b32 s55, s55, 7
    s_lshl_b32 s55, s55, 10
    s_add_u32 s9, s55, s53
    s_add_u32 s55, s48, 7
    s_and_b32 s55, s55, 7
    s_lshl_b32 s55, s55, 10
    s_add_u32 s10, s55, s53
    s_mov_b64 exec, 0xff
    s_waitcnt vmcnt(0)
    buffer_store_dword v20, v22, s[44:47], s54 offen sc1
    s_mov_b32 s64, 0
    v_mov_b32 v140, 0
    buffer_atomic_or v140, v11, s[44:47], s68 offen sc0 sc1
    s_sleep 2
L_poll2:
    v_mov_b32 v141, 0
    buffer_atomic_or v141, v11, s[44:47], s68 offen sc0 sc1
    s_waitcnt vmcnt(1)
    v_cmp_ne_u32 vcc, s59, v140
    s_cbranch_vccz L_poll2_done
    s_sleep 2
    v_mov_b32 v140, 0
    buffer_atomic_or v140, v11, s[44:47], s68 offen sc0 sc1
    s_waitcnt vmcnt(1)
    v_cmp_ne_u32 vcc, s59, v141
    s_cbranch_vccz L_poll2_done
    s_sleep 2
    s_add_u32 s64, s64, 1
    s_cmp_lt_u32 s64, 50000
    s_cbranch_scc1 L_poll2
L_poll2_done:
    s_mov_b64 exec, -1
    buffer_load_dwordx4 v[196:199], v10, s[44:47], s4 offen sc1
    buffer_load_dwordx4 v[200:203], v10, s[44:47], s5 offen sc1
    buffer_load_dwordx4 v[204:207], v10, s[44:47], s6 offen sc1
    buffer_load_dwordx4 v[208:211], v10, s[44:47], s7 offen sc1
    buffer_load_dwordx4 v[212:215], v10, s[44:47], s8 offen sc1
    buffer_load_dwordx4 v[216:219], v10, s[44:47], s9 offen sc1
    buffer_load_dwordx4 v[220:223], v10, s[44:47], s10 offen sc1
    s_mov_b32 s57, 0xffff0000
    s_waitcnt vmcnt(6)
    v_lshlrev_b32 v148, 16, v196
    v_and_b32 v149, s57, v196
    v_lshlrev_b32 v150, 16, v197
    v_and_b32 v151, s57, v197
    v_lshlrev_b32 v152, 16, v198
    v_and_b32 v153, s57, v198
    v_lshlrev_b32 v154, 16, v199
    v_and_b32 v155, s57, v199
    v_pk_add_f32 v[2:3], v[2:3], v[148:149]
    v_pk_add_f32 v[4:5], v[4:5], v[150:151]
    v_pk_add_f32 v[6:7], v[6:7], v[152:153]
    v_pk_add_f32 v[8:9], v[8:9], v[154:155]
    s_waitcnt vmcnt(5)
    v_lshlrev_b32 v148, 16, v200
    v_and_b32 v149, s57, v200
    v_lshlrev_b32 v150, 16, v201
    v_and_b32 v151, s57, v201
    v_lshlrev_b32 v152, 16, v202
    v_and_b32 v153, s57, v202
    v_lshlrev_b32 v154, 16, v203
    v_and_b32 v155, s57, v203
    v_pk_add_f32 v[2:3], v[2:3], v[148:149]
    v_pk_add_f32 v[4:5], v[4:5], v[150:151]
    v_pk_add_f32 v[6:7], v[6:7], v[152:153]
    v_pk_add_f32 v[8:9], v[8:9], v[154:155]
    s_waitcnt vmcnt(4)
    v_lshlrev_b32 v148, 16, v204
    v_and_b32 v149, s57, v204
    v_lshlrev_b32 v150, 16, v205
    v_and_b32 v151, s57, v205
    v_lshlrev_b32 v152, 16, v206
    v_and_b32 v153, s57, v206
    v_lshlrev_b32 v154, 16, v207
    v_and_b32 v155, s57, v207
    v_pk_add_f32 v[2:3], v[2:3], v[148:149]
    v_pk_add_f32 v[4:5], v[4:5], v[150:151]
    v_pk_add_f32 v[6:7], v[6:7], v[152:153]
    v_pk_add_f32 v[8:9], v[8:9], v[154:155]
    s_waitcnt vmcnt(3)
    v_lshlrev_b32 v148, 16, v208
    v_and_b32 v149, s57, v208
    v_lshlrev_b32 v150, 16, v209
    v_and_b32 v151, s57, v209
    v_lshlrev_b32 v152, 16, v210
    v_and_b32 v153, s57, v210
    v_lshlrev_b32 v154, 16, v211
    v_and_b32 v155, s57, v211
    v_pk_add_f32 v[2:3], v[2:3], v[148:149]
    v_pk_add_f32 v[4:5], v[4:5], v[150:151]
    v_pk_add_f32 v[6:7], v[6:7], v[152:153]
    v_pk_add_f32 v[8:9], v[8:9], v[154:155]
    s_waitcnt vmcnt(2)
    v_lshlrev_b32 v148, 16, v212
    v_and_b32 v149, s57, v212
    v_lshlrev_b32 v150, 16, v213
    v_and_b32 v151, s57, v213
    v_lshlrev_b32 v152, 16, v214
    v_and_b32 v153, s57, v214
    v_lshlrev_b32 v154, 16, v215
    v_and_b32 v155, s57, v215
    v_pk_add_f32 v[2:3], v[2:3], v[148:149]
    v_pk_add_f32 v[4:5], v[4:5], v[150:151]
    v_pk_add_f32 v[6:7], v[6:7], v[152:153]
    v_pk_add_f32 v[8:9], v[8:9], v[154:155]
    s_waitcnt vmcnt(1)
    v_lshlrev_b32 v148, 16, v216
    v_and_b32 v149, s57, v216
    v_lshlrev_b32 v150, 16, v217
    v_and_b32 v151, s57, v217
    v_lshlrev_b32 v152, 16, v218
    v_and_b32 v153, s57, v218
    v_lshlrev_b32 v154, 16, v219
    v_and_b32 v155, s57, v219
    v_pk_add_f32 v[2:3], v[2:3], v[148:149]
    v_pk_add_f32 v[4:5], v[4:5], v[150:151]
    v_pk_add_f32 v[6:7], v[6:7], v[152:153]
    v_pk_add_f32 v[8:9], v[8:9], v[154:155]
    s_waitcnt vmcnt(0)
    v_lshlrev_b32 v148, 16, v220
    v_and_b32 v149, s57, v220
    v_lshlrev_b32 v150, 16, v221
    v_and_b32 v151, s57, v221
    v_lshlrev_b32 v152, 16, v222
    v_and_b32 v153, s57, v222
    v_lshlrev_b32 v154, 16, v223
    v_and_b32 v155, s57, v223
    v_pk_add_f32 v[2:3], v[2:3], v[148:149]
    v_pk_add_f32 v[4:5], v[4:5], v[150:151]
    v_pk_add_f32 v[6:7], v[6:7], v[152:153]
    v_pk_add_f32 v[8:9], v[8:9], v[154:155]
    v_cvt_pk_bf16_f32 v32, v2, v3
    v_cvt_pk_bf16_f32 v33, v4, v5
    s_lshl_b32 s53, s48, 1
    s_add_u32 s53, s53, 0
    s_mul_i32 s55, s53, 13
    s_lshr_b32 s55, s55, 6
    s_mul_i32 s54, s55, 5
    s_sub_u32 s54, s53, s54
    s_lshl_b32 s54, s54, 5
    s_mul_i32 s55, s55, 20480
    s_add_u32 s63, s69, s54
    s_add_u32 s63, s63, s55
    buffer_store_dwordx2 v[32:33], v12, s[40:43], s63 offen
    v_cvt_pk_bf16_f32 v34, v6, v7
    v_cvt_pk_bf16_f32 v35, v8, v9
    s_lshl_b32 s53, s48, 1
    s_add_u32 s53, s53, 1
    s_cmp_eq_u32 s53, 15
    s_cbranch_scc1 L_fin
    s_mul_i32 s55, s53, 13
    s_lshr_b32 s55, s55, 6
    s_mul_i32 s54, s55, 5
    s_sub_u32 s54, s53, s54
    s_lshl_b32 s54, s54, 5
    s_mul_i32 s55, s55, 20480
    s_add_u32 s63, s69, s54
    s_add_u32 s63, s63, s55
    buffer_store_dwordx2 v[34:35], v12, s[40:43], s63 offen
L_fin:
    s_or_b32 s53, s48, s49
    s_or_b32 s53, s53, s61
    s_cmp_lg_u32 s53, 0
    s_cbranch_scc1 L_noep
    s_barrier
    s_cmp_lg_u32 s52, 0
    s_cbranch_scc1 L_noep
    s_lshl_b32 s55, s50, 7
    s_add_u32 s55, s55, 3276800
    s_mov_b64 exec, 1
    buffer_store_dword v20, v21, s[44:47], s55 offen sc1
    s_mov_b64 exec, -1
L_noep:
L_end:
    s_endpgm
L_sl1:
    s_nop 7
    v_mfma_f32_16x16x32_bf16 v[68:71], v[40:43], v[216:219], v[110:113]
    v_mfma_f32_16x16x32_bf16 v[72:75], v[52:55], v[216:219], v[146:149]
    v_mfma_f32_16x16x32_bf16 v[76:79], v[64:67], v[216:219], v[236:239]
    v_mfma_f32_16x16x32_bf16 v[122:125], v[40:43], v[220:223], v[122:125]
    v_mfma_f32_16x16x32_bf16 v[158:161], v[52:55], v[220:223], v[158:161]
    v_mfma_f32_16x16x32_bf16 v[26:29], v[64:67], v[220:223], v[26:29]
    v_mfma_f32_16x16x32_bf16 v[110:113], v[40:43], v[224:227], v[134:137]
    v_mfma_f32_16x16x32_bf16 v[146:149], v[52:55], v[224:227], v[164:167]
    v_mfma_f32_16x16x32_bf16 v[236:239], v[64:67], v[224:227], v[182:185]
    ds_write_b128 v180, v[68:71] offset:0
    ds_write_b128 v180, v[72:75] offset:1024
    ds_write_b128 v180, v[76:79] offset:2048
    ds_write_b128 v180, v[122:125] offset:3072
    ds_write_b128 v180, v[158:161] offset:4096
    ds_write_b128 v180, v[26:29] offset:5120
    s_branch L_sld
L_pp1:
    buffer_store_dwordx2 v[158:159], v13, s[44:47], s66 offen offset:3072 sc1
    s_branch L_ppd
L_own0:
    s_nop 7
    v_mov_b32 v2, v68
    v_mov_b32 v3, v69
    v_mov_b32 v4, v70
    v_mov_b32 v5, v71
    v_mov_b32 v6, v72
    v_mov_b32 v7, v73
    v_mov_b32 v8, v74
    v_mov_b32 v9, v75
    s_branch L_ownr0
L_own1:
    s_nop 7
    v_mov_b32 v2, v76
    v_mov_b32 v3, v77
    v_mov_b32 v4, v78
    v_mov_b32 v5, v79
    v_mov_b32 v6, v80
    v_mov_b32 v7, v81
    v_mov_b32 v8, v82
    v_mov_b32 v9, v83
    s_branch L_ownr1
L_own2:
    s_nop 7
    v_mov_b32 v2, v84
    v_mov_b32 v3, v85
    v_mov_b32 v4, v86
    v_mov_b32 v5, v87
    v_mov_b32 v6, v88
    v_mov_b32 v7, v89
    v_mov_b32 v8, v90
    v_mov_b32 v9, v91
    s_branch L_ownr2
L_own3:
    s_nop 7
    v_mov_b32 v2, v92
    v_mov_b32 v3, v93
    v_mov_b32 v4, v94
    v_mov_b32 v5, v95
    v_mov_b32 v6, v96
    v_mov_b32 v7, v97
    v_mov_b32 v8, v98
    v_mov_b32 v9, v99
    s_branch L_ownr3
L_own4:
    s_nop 7
    v_mov_b32 v2, v100
    v_mov_b32 v3, v101
    v_mov_b32 v4, v102
    v_mov_b32 v5, v103
    v_mov_b32 v6, v176
    v_mov_b32 v7, v177
    v_mov_b32 v8, v178
    v_mov_b32 v9, v179
    s_branch L_ownr4
L_own5:
    s_nop 7
    v_mov_b32 v2, v194
    v_mov_b32 v3, v195
    v_mov_b32 v4, v196
    v_mov_b32 v5, v197
    v_mov_b32 v6, v212
    v_mov_b32 v7, v213
    v_mov_b32 v8, v214
    v_mov_b32 v9, v215
    s_branch L_ownr5
L_own6:
    s_nop 7
    v_mov_b32 v2, v230
    v_mov_b32 v3, v231
    v_mov_b32 v4, v232
    v_mov_b32 v5, v233
    v_mov_b32 v6, v248
    v_mov_b32 v7, v249
    v_mov_b32 v8, v250
    v_mov_b32 v9, v251
    s_branch L_ownr6
L_own7:
    s_nop 7
    v_mov_b32 v2, v26
    v_mov_b32 v3, v27
    v_mov_b32 v4, v28
    v_mov_b32 v5, v29
    v_mov_b32 v6, v26
    v_mov_b32 v7, v27
    v_mov_b32 v8, v28
    v_mov_b32 v9, v29
    s_branch L_ownr7
L_slow0:
    ds_read_b32 v15, v14 offset:0
    s_add_u32 s17, s17, 1
    s_cmp_gt_u32 s17, 2000000
    s_cbranch_scc1 L_cont0
    s_waitcnt lgkmcnt(0)
    v_cmp_ne_u32 vcc, 0, v15
    s_cbranch_vccnz L_slow0
    s_branch L_cont0
L_slow1:
    ds_read_b32 v15, v14 offset:16
    s_add_u32 s17, s17, 1
    s_cmp_gt_u32 s17, 2000000
    s_cbranch_scc1 L_cont1
    s_waitcnt lgkmcnt(0)
    v_cmp_ne_u32 vcc, 0, v15
    s_cbranch_vccnz L_slow1
    s_branch L_cont1
L_slow2:
    ds_read_b32 v15, v14 offset:32
    s_add_u32 s17, s17, 1
    s_cmp_gt_u32 s17, 2000000
    s_cbranch_scc1 L_cont2
    s_waitcnt lgkmcnt(0)
    v_cmp_ne_u32 vcc, 0, v15
    s_cbranch_vccnz L_slow2
    s_branch L_cont2
L_slow3:
    ds_read_b32 v15, v14 offset:48
    s_add_u32 s17, s17, 1
    s_cmp_gt_u32 s17, 2000000
    s_cbranch_scc1 L_cont3
    s_waitcnt lgkmcnt(0)
    v_cmp_ne_u32 vcc, 0, v15
    s_cbranch_vccnz L_slow3
    s_branch L_cont3
L_slow4:
    ds_read_b32 v15, v14 offset:64
    s_add_u32 s17, s17, 1
    s_cmp_gt_u32 s17, 2000000
    s_cbranch_scc1 L_cont4
    s_waitcnt lgkmcnt(0)
    v_cmp_ne_u32 vcc, 0, v15
    s_cbranch_vccnz L_slow4
    s_branch L_cont4
L_slow5:
    ds_read_b32 v15, v14 offset:80
    s_add_u32 s17, s17, 1
    s_cmp_gt_u32 s17, 2000000
    s_cbranch_scc1 L_cont5
    s_waitcnt lgkmcnt(0)
    v_cmp_ne_u32 vcc, 0, v15
    s_cbranch_vccnz L_slow5
    s_branch L_cont5
L_slow6:
    ds_read_b32 v15, v14 offset:96
    s_add_u32 s17, s17, 1
    s_cmp_gt_u32 s17, 2000000
    s_cbranch_scc1 L_cont6
    s_waitcnt lgkmcnt(0)
    v_cmp_ne_u32 vcc, 0, v15
    s_cbranch_vccnz L_slow6
    s_branch L_cont6
L_slow7:
    ds_read_b32 v15, v14 offset:112
    s_add_u32 s17, s17, 1
    s_cmp_gt_u32 s17, 2000000
    s_cbranch_scc1 L_cont7
    s_waitcnt lgkmcnt(0)
    v_cmp_ne_u32 vcc, 0, v15
    s_cbranch_vccnz L_slow7
    s_branch L_cont7
L_slow8:
    ds_read_b32 v15, v14 offset:128
    s_add_u32 s17, s17, 1
    s_cmp_gt_u32 s17, 2000000
    s_cbranch_scc1 L_cont8
    s_waitcnt lgkmcnt(0)
    v_cmp_ne_u32 vcc, 0, v15
    s_cbranch_vccnz L_slow8
    s_branch L_cont8
L_slow9:
    ds_read_b32 v15, v14 offset:144
    s_add_u32 s17, s17, 1
    s_cmp_gt_u32 s17, 2000000
    s_cbranch_scc1 L_cont9
    s_waitcnt lgkmcnt(0)
    v_cmp_ne_u32 vcc, 0, v15
    s_cbranch_vccnz L_slow9
    s_branch L_cont9
L_slow10:
    ds_read_b32 v15, v14 offset:160
    s_add_u32 s17, s17, 1
    s_cmp_gt_u32 s17, 2000000
    s_cbranch_scc1 L_cont10
    s_waitcnt lgkmcnt(0)
    v_cmp_ne_u32 vcc, 0, v15
    s_cbranch_vccnz L_slow10
    s_branch L_cont10
L_slow16:
    ds_read_b32 v15, v14 offset:256
    s_add_u32 s17, s17, 1
    s_cmp_gt_u32 s17, 2000000
    s_cbranch_scc1 L_cont16
    s_waitcnt lgkmcnt(0)
    v_cmp_ne_u32 vcc, 0, v15
    s_cbranch_vccnz L_slow16
    s_branch L_cont16
L_slow17:
    ds_read_b32 v15, v14 offset:272
    s_add_u32 s17, s17, 1
    s_cmp_gt_u32 s17, 2000000
    s_cbranch_scc1 L_cont17
    s_waitcnt lgkmcnt(0)
    v_cmp_ne_u32 vcc, 0, v15
    s_cbranch_vccnz L_slow17
    s_branch L_cont17
L_slow18:
    ds_read_b32 v15, v14 offset:288
    s_add_u32 s17, s17, 1
    s_cmp_gt_u32 s17, 2000000
    s_cbranch_scc1 L_cont18
    s_waitcnt lgkmcnt(0)
    v_cmp_ne_u32 vcc, 0, v15
    s_cbranch_vccnz L_slow18
    s_branch L_cont18
L_slow19:
    ds_read_b32 v15, v14 offset:304
    s_add_u32 s17, s17, 1
    s_cmp_gt_u32 s17, 2000000
    s_cbranch_scc1 L_cont19
    s_waitcnt lgkmcnt(0)
    v_cmp_ne_u32 vcc, 0, v15
    s_cbranch_vccnz L_slow19
    s_branch L_cont19
L_slow20:
    ds_read_b32 v15, v14 offset:320
    s_add_u32 s17, s17, 1
    s_cmp_gt_u32 s17, 2000000
    s_cbranch_scc1 L_cont20
    s_waitcnt lgkmcnt(0)
    v_cmp_ne_u32 vcc, 0, v15
    s_cbranch_vccnz L_slow20
    s_branch L_cont20
L_slow21:
    ds_read_b32 v15, v14 offset:336
    s_add_u32 s17, s17, 1
    s_cmp_gt_u32 s17, 2000000
    s_cbranch_scc1 L_cont21
    s_waitcnt lgkmcnt(0)
    v_cmp_ne_u32 vcc, 0, v15
    s_cbranch_vccnz L_slow21
    s_branch L_cont21
L_slow22:
    ds_read_b32 v15, v14 offset:352
    s_add_u32 s17, s17, 1
    s_cmp_gt_u32 s17, 2000000
    s_cbranch_scc1 L_cont22
    s_waitcnt lgkmcnt(0)
    v_cmp_ne_u32 vcc, 0, v15
    s_cbranch_vccnz L_slow22
    s_branch L_cont22
L_slow23:
    ds_read_b32 v15, v14 offset:368
    s_add_u32 s17, s17, 1
    s_cmp_gt_u32 s17, 2000000
    s_cbranch_scc1 L_cont23
    s_waitcnt lgkmcnt(0)
    v_cmp_ne_u32 vcc, 0, v15
    s_cbranch_vccnz L_slow23
    s_branch L_cont23
L_slow24:
    ds_read_b32 v15, v14 offset:384
    s_add_u32 s17, s17, 1
    s_cmp_gt_u32 s17, 2000000
    s_cbranch_scc1 L_cont24
    s_waitcnt lgkmcnt(0)
    v_cmp_ne_u32 vcc, 0, v15
    s_cbranch_vccnz L_slow24
    s_branch L_cont24
L_slow25:
    ds_read_b32 v15, v14 offset:400
    s_add_u32 s17, s17, 1
    s_cmp_gt_u32 s17, 2000000
    s_cbranch_scc1 L_cont25
    s_waitcnt lgkmcnt(0)
    v_cmp_ne_u32 vcc, 0, v15
    s_cbranch_vccnz L_slow25
    s_branch L_cont25
L_slow26:
    ds_read_b32 v15, v14 offset:416
    s_add_u32 s17, s17, 1
    s_cmp_gt_u32 s17, 2000000
    s_cbranch_scc1 L_cont26
    s_waitcnt lgkmcnt(0)
    v_cmp_ne_u32 vcc, 0, v15
    s_cbranch_vccnz L_slow26
    s_branch L_cont26
L_slow27:
    ds_read_b32 v15, v14 offset:432
    s_add_u32 s17, s17, 1
    s_cmp_gt_u32 s17, 2000000
    s_cbranch_scc1 L_cont27
    s_waitcnt lgkmcnt(0)
    v_cmp_ne_u32 vcc, 0, v15
    s_cbranch_vccnz L_slow27
    s_branch L_cont27
L_slow30:
    ds_read_b32 v15, v14 offset:480
    s_add_u32 s17, s17, 1
    s_cmp_gt_u32 s17, 2000000
    s_cbranch_scc1 L_cont30
    s_waitcnt lgkmcnt(0)
    v_cmp_ne_u32 vcc, 0, v15
    s_cbranch_vccnz L_slow30
    s_branch L_cont30
.p2align 8
.fill 4096, 4, 0xBF810000
.section .rodata,"a"
.p2align 6
.amdhsa_kernel standalone__mha_block_cached__near_ridge_kernel
  .amdhsa_next_free_vgpr 256
  .amdhsa_next_free_sgpr 102
  .amdhsa_accum_offset 256
  .amdhsa_group_segment_fixed_size 0
  .amdhsa_kernarg_size 64
  .amdhsa_user_sgpr_count 2
  .amdhsa_user_sgpr_kernarg_segment_ptr 1
  .amdhsa_system_sgpr_workgroup_id_x 1
.end_amdhsa_kernel
```
